```python
import torch

def _softmax(x, axis=-1):
    return torch.softmax(x, dim=axis)

def _gelu(x):
    return torch.nn.functional.gelu(x, approximate='tanh')

def _silu(x):
    return torch.nn.functional.silu(x)

def _sigmoid(x):
    return torch.sigmoid(x)

def _layernorm(x, axis=-1, eps=1e-05):
    m = x.mean(dim=axis, keepdim=True)
    v = x.var(dim=axis, keepdim=True, unbiased=False)
    return (x - m) / torch.sqrt(v + eps)

def _scatter_add(tgt, idx, src, axis=0):
    return tgt.clone().index_add_(axis, idx, src)

def _segment_sum(src, seg, n):
    out = torch.zeros((n,) + src.shape[1:], dtype=src.dtype)
    return out.index_add_(0, seg, src)

def _pad(x, pw):
    flat = tuple((v for pair in reversed(pw) for v in pair))
    return torch.nn.functional.pad(x, flat)
kernel_name = 'standalone__tree_speculative_verify_tree_attention_over_candidate_token_tree__decode'

def setup_inputs():

    _w = lambda a: (lambda t: t.to(torch.bfloat16) if t.is_floating_point() else t)(torch.as_tensor(a))
    B, Hq, Hkv, T, C, D = (1, 32, 32, 1, 8192, 192)
    tree_mask = torch.zeros((B, T, T), dtype=float)
    for b in range(B):
        parent = torch.zeros(T, dtype=torch.int64)
        for i in range(1, T):
            parent[i] = int(torch.randint(0, i, (1,)).item())
        for i in range(T):
            j = i
            tree_mask[b, i, j] = 1.0
            while j > 0:
                j = parent[j]
                tree_mask[b, i, j] = 1.0
    return {'q': _w((lambda *s: torch.randn(*s, dtype=torch.bfloat16) * 0.8)(B, Hq, T, D)), 'k_cache': _w((lambda *s: torch.randn(*s, dtype=torch.bfloat16) * 0.8)(B, Hkv, C, D)), 'v_cache': _w((lambda *s: torch.randn(*s, dtype=torch.bfloat16) * 0.05)(B, Hkv, C, D)), 'k_tree': _w((lambda *s: torch.randn(*s, dtype=torch.bfloat16) * 0.8)(B, Hkv, T, D)), 'v_tree': _w((lambda *s: torch.randn(*s, dtype=torch.bfloat16) * 0.05)(B, Hkv, T, D)), 'tree_mask': _w(tree_mask)}

def reference(q, k_cache, v_cache, k_tree, v_tree, tree_mask):
    B, Hq, T, D = q.shape
    Hkv, C = (k_cache.shape[1], k_cache.shape[2])
    rep = Hq // Hkv
    kc = (lambda x, n, axis: torch.repeat_interleave(x, n, dim=axis))(k_cache, rep, axis=1)
    vc = (lambda x, n, axis: torch.repeat_interleave(x, n, dim=axis))(v_cache, rep, axis=1)
    kt = (lambda x, n, axis: torch.repeat_interleave(x, n, dim=axis))(k_tree, rep, axis=1)
    vt = (lambda x, n, axis: torch.repeat_interleave(x, n, dim=axis))(v_tree, rep, axis=1)
    k = torch.concatenate([kc, kt], axis=2)
    v = torch.concatenate([vc, vt], axis=2)
    scale = D ** (-0.5)
    scores = torch.einsum('bhqd,bhkd->bhqk', q, k) * scale
    ctx_mask = torch.ones((B, 1, T, C), dtype=scores.dtype)
    tm = tree_mask[:, None, :, :].clone()
    full_mask = torch.concatenate([ctx_mask, tm], axis=-1)
    scores = scores + (1.0 - full_mask) * -1000000000.0
    p = _softmax(scores, axis=-1)
    return torch.einsum('bhqk,bhkd->bhqd', p, v)
```

```asm
; @launch grid=(256,1,1) block=(256,1,1) lds=4096
.amdgcn_target "amdgcn-amd-amdhsa--gfx950"
.text
.globl standalone__tree_speculative_verify_tree_attention_over_candidate_token_tree__decode_kernel
.p2align 8
.type standalone__tree_speculative_verify_tree_attention_over_candidate_token_tree__decode_kernel,@function
standalone__tree_speculative_verify_tree_attention_over_candidate_token_tree__decode_kernel:
  s_cmp_ge_u32 s2, 256
  s_cbranch_scc1 L_end
  s_load_dwordx16 s[4:19], s[0:1], 0
  s_load_dwordx2 s[20:21], s[0:1], 64
  s_lshr_b32 s60, s2, 3
  s_and_b32 s61, s2, 7
  s_lshl_b32 s62, s60, 3
  s_add_u32 s62, s62, s61
  s_mul_i32 s62, s62, 393216
  s_mul_i32 s63, s60, 384
  v_lshrrev_b32 v3, 6, v0
  v_and_b32 v2, 7, v0
  v_lshlrev_b32 v2, 4, v2
  v_bfe_u32 v1, v0, 3, 3
  v_mul_u32_u24 v1, 384, v1
  v_add_u32 v1, v1, v2
  s_mov_b32 s65, 3072
  v_mul_lo_u32 v92, v3, s65
  v_add_u32 v1, v1, v92
  v_readfirstlane_b32 s66, v3
  v_and_b32 v92, 63, v0
  v_lshrrev_b32 v93, 3, v92
  v_mul_u32_u24 v93, 3, v93
  v_and_b32 v94, 7, v92
  v_lshlrev_b32 v94, 4, v94
  v_add_u32 v95, 0, v93
  v_lshrrev_b32 v96, 3, v95
  v_lshlrev_b32 v96, 7, v96
  v_and_b32 v95, 7, v95
  v_lshlrev_b32 v95, 1, v95
  v_add3_u32 v88, v96, v95, v94
  v_add_u32 v95, 1, v93
  v_lshrrev_b32 v96, 3, v95
  v_lshlrev_b32 v96, 7, v96
  v_and_b32 v95, 7, v95
  v_lshlrev_b32 v95, 1, v95
  v_add3_u32 v89, v96, v95, v94
  v_add_u32 v95, 2, v93
  v_lshrrev_b32 v96, 3, v95
  v_lshlrev_b32 v96, 7, v96
  v_and_b32 v95, 7, v95
  v_lshlrev_b32 v95, 1, v95
  v_add3_u32 v90, v96, v95, v94
  s_mov_b32 s67, 0xffff0000
  s_waitcnt lgkmcnt(0)
  s_add_u32 s24, s6, s62
  s_addc_u32 s25, s7, 0
  s_mov_b32 s26, 393216
  s_mov_b32 s27, 0x20000
  s_add_u32 s32, s4, s63
  s_addc_u32 s33, s5, 0
  s_mov_b32 s34, 384
  s_mov_b32 s35, 0x20000
  buffer_load_dwordx4 v[4:7], v2, s[32:35], 0 offen offset:0
  buffer_load_dwordx4 v[8:11], v2, s[32:35], 0 offen offset:128
  buffer_load_dwordx4 v[12:15], v2, s[32:35], 0 offen offset:256
  buffer_load_dwordx4 v[108:111], v1, s[24:27], 0 offen offset:0 nt
  buffer_load_dwordx4 v[112:115], v1, s[24:27], 0 offen offset:128 nt
  buffer_load_dwordx4 v[116:119], v1, s[24:27], 0 offen offset:256 nt
  s_mov_b32 s64, 12288
  buffer_load_dwordx4 v[120:123], v1, s[24:27], s64 offen offset:0 nt
  buffer_load_dwordx4 v[124:127], v1, s[24:27], s64 offen offset:128 nt
  buffer_load_dwordx4 v[128:131], v1, s[24:27], s64 offen offset:256 nt
  s_mov_b32 s64, 24576
  buffer_load_dwordx4 v[132:135], v1, s[24:27], s64 offen offset:0 nt
  buffer_load_dwordx4 v[136:139], v1, s[24:27], s64 offen offset:128 nt
  buffer_load_dwordx4 v[140:143], v1, s[24:27], s64 offen offset:256 nt
  s_mov_b32 s64, 36864
  buffer_load_dwordx4 v[144:147], v1, s[24:27], s64 offen offset:0 nt
  buffer_load_dwordx4 v[148:151], v1, s[24:27], s64 offen offset:128 nt
  buffer_load_dwordx4 v[152:155], v1, s[24:27], s64 offen offset:256 nt
  s_mov_b32 s64, 49152
  buffer_load_dwordx4 v[156:159], v1, s[24:27], s64 offen offset:0 nt
  buffer_load_dwordx4 v[160:163], v1, s[24:27], s64 offen offset:128 nt
  buffer_load_dwordx4 v[164:167], v1, s[24:27], s64 offen offset:256 nt
  s_mov_b32 s64, 61440
  buffer_load_dwordx4 v[168:171], v1, s[24:27], s64 offen offset:0 nt
  buffer_load_dwordx4 v[172:175], v1, s[24:27], s64 offen offset:128 nt
  buffer_load_dwordx4 v[176:179], v1, s[24:27], s64 offen offset:256 nt
  s_mov_b32 s64, 73728
  buffer_load_dwordx4 v[180:183], v1, s[24:27], s64 offen offset:0 nt
  buffer_load_dwordx4 v[184:187], v1, s[24:27], s64 offen offset:128 nt
  buffer_load_dwordx4 v[188:191], v1, s[24:27], s64 offen offset:256 nt
  s_mov_b32 s64, 86016
  buffer_load_dwordx4 v[192:195], v1, s[24:27], s64 offen offset:0 nt
  buffer_load_dwordx4 v[196:199], v1, s[24:27], s64 offen offset:128 nt
  buffer_load_dwordx4 v[200:203], v1, s[24:27], s64 offen offset:256 nt
  s_mov_b32 s64, 98304
  buffer_load_dwordx4 v[204:207], v1, s[24:27], s64 offen offset:0 nt
  buffer_load_dwordx4 v[208:211], v1, s[24:27], s64 offen offset:128 nt
  buffer_load_dwordx4 v[212:215], v1, s[24:27], s64 offen offset:256 nt
  s_mov_b32 s64, 110592
  buffer_load_dwordx4 v[216:219], v1, s[24:27], s64 offen offset:0 nt
  buffer_load_dwordx4 v[220:223], v1, s[24:27], s64 offen offset:128 nt
  buffer_load_dwordx4 v[224:227], v1, s[24:27], s64 offen offset:256 nt
  s_mov_b32 s64, 122880
  buffer_load_dwordx4 v[228:231], v1, s[24:27], s64 offen offset:0 nt
  buffer_load_dwordx4 v[232:235], v1, s[24:27], s64 offen offset:128 nt
  buffer_load_dwordx4 v[236:239], v1, s[24:27], s64 offen offset:256 nt
  s_mov_b32 s64, 135168
  buffer_load_dwordx4 v[240:243], v1, s[24:27], s64 offen offset:0 nt
  buffer_load_dwordx4 v[244:247], v1, s[24:27], s64 offen offset:128 nt
  buffer_load_dwordx4 v[248:251], v1, s[24:27], s64 offen offset:256 nt
  s_add_u32 s28, s8, s62
  s_addc_u32 s29, s9, 0
  s_mov_b32 s30, 393216
  s_mov_b32 s31, 0x20000
  s_add_u32 s36, s10, s63
  s_addc_u32 s37, s11, 0
  s_mov_b32 s38, 384
  s_mov_b32 s39, 0x20000
  s_add_u32 s40, s12, s63
  s_addc_u32 s41, s13, 0
  s_mov_b32 s42, 384
  s_mov_b32 s43, 0x20000
  s_mov_b32 s44, s14
  s_mov_b32 s45, s15
  s_mov_b32 s46, 2
  s_mov_b32 s47, 0x20000
  s_add_u32 s48, s16, s63
  s_addc_u32 s49, s17, 0
  s_mov_b32 s50, 384
  s_mov_b32 s51, 0x20000
  s_lshl_b32 s62, s60, 13
  s_add_u32 s52, s20, s62
  s_addc_u32 s53, s21, 0
  s_mov_b32 s54, 8192
  s_mov_b32 s55, 0x20000
  s_waitcnt vmcnt(33)
  v_dot2_f32_bf16 v16, v108, v4, 0
  v_dot2_f32_bf16 v16, v109, v5, v16
  v_dot2_f32_bf16 v16, v110, v6, v16
  v_dot2_f32_bf16 v16, v111, v7, v16
  v_dot2_f32_bf16 v16, v112, v8, v16
  v_dot2_f32_bf16 v16, v113, v9, v16
  v_dot2_f32_bf16 v16, v114, v10, v16
  v_dot2_f32_bf16 v16, v115, v11, v16
  v_dot2_f32_bf16 v16, v116, v12, v16
  v_dot2_f32_bf16 v16, v117, v13, v16
  v_dot2_f32_bf16 v16, v118, v14, v16
  v_dot2_f32_bf16 v16, v119, v15, v16
  s_nop 2
  v_add_f32_dpp v16, v16, v16 quad_perm:[1,0,3,2] row_mask:0xf bank_mask:0xf
  s_nop 1
  v_add_f32_dpp v16, v16, v16 quad_perm:[2,3,0,1] row_mask:0xf bank_mask:0xf
  s_nop 1
  v_add_f32_dpp v16, v16, v16 row_half_mirror row_mask:0xf bank_mask:0xf
  s_mov_b32 s64, 147456
  buffer_load_dwordx4 v[108:111], v1, s[24:27], s64 offen offset:0 nt
  buffer_load_dwordx4 v[112:115], v1, s[24:27], s64 offen offset:128 nt
  buffer_load_dwordx4 v[116:119], v1, s[24:27], s64 offen offset:256 nt
  s_waitcnt vmcnt(33)
  v_dot2_f32_bf16 v17, v120, v4, 0
  v_dot2_f32_bf16 v17, v121, v5, v17
  v_dot2_f32_bf16 v17, v122, v6, v17
  v_dot2_f32_bf16 v17, v123, v7, v17
  v_dot2_f32_bf16 v17, v124, v8, v17
  v_dot2_f32_bf16 v17, v125, v9, v17
  v_dot2_f32_bf16 v17, v126, v10, v17
  v_dot2_f32_bf16 v17, v127, v11, v17
  v_dot2_f32_bf16 v17, v128, v12, v17
  v_dot2_f32_bf16 v17, v129, v13, v17
  v_dot2_f32_bf16 v17, v130, v14, v17
  v_dot2_f32_bf16 v17, v131, v15, v17
  s_nop 2
  v_add_f32_dpp v17, v17, v17 quad_perm:[1,0,3,2] row_mask:0xf bank_mask:0xf
  s_nop 1
  v_add_f32_dpp v17, v17, v17 quad_perm:[2,3,0,1] row_mask:0xf bank_mask:0xf
  s_nop 1
  v_add_f32_dpp v17, v17, v17 row_half_mirror row_mask:0xf bank_mask:0xf
  s_mov_b32 s64, 159744
  buffer_load_dwordx4 v[120:123], v1, s[24:27], s64 offen offset:0 nt
  buffer_load_dwordx4 v[124:127], v1, s[24:27], s64 offen offset:128 nt
  buffer_load_dwordx4 v[128:131], v1, s[24:27], s64 offen offset:256 nt
  s_waitcnt vmcnt(33)
  v_dot2_f32_bf16 v18, v132, v4, 0
  v_dot2_f32_bf16 v18, v133, v5, v18
  v_dot2_f32_bf16 v18, v134, v6, v18
  v_dot2_f32_bf16 v18, v135, v7, v18
  v_dot2_f32_bf16 v18, v136, v8, v18
  v_dot2_f32_bf16 v18, v137, v9, v18
  v_dot2_f32_bf16 v18, v138, v10, v18
  v_dot2_f32_bf16 v18, v139, v11, v18
  v_dot2_f32_bf16 v18, v140, v12, v18
  v_dot2_f32_bf16 v18, v141, v13, v18
  v_dot2_f32_bf16 v18, v142, v14, v18
  v_dot2_f32_bf16 v18, v143, v15, v18
  s_nop 2
  v_add_f32_dpp v18, v18, v18 quad_perm:[1,0,3,2] row_mask:0xf bank_mask:0xf
  s_nop 1
  v_add_f32_dpp v18, v18, v18 quad_perm:[2,3,0,1] row_mask:0xf bank_mask:0xf
  s_nop 1
  v_add_f32_dpp v18, v18, v18 row_half_mirror row_mask:0xf bank_mask:0xf
  s_mov_b32 s64, 172032
  buffer_load_dwordx4 v[132:135], v1, s[24:27], s64 offen offset:0 nt
  buffer_load_dwordx4 v[136:139], v1, s[24:27], s64 offen offset:128 nt
  buffer_load_dwordx4 v[140:143], v1, s[24:27], s64 offen offset:256 nt
  s_waitcnt vmcnt(33)
  v_dot2_f32_bf16 v19, v144, v4, 0
  v_dot2_f32_bf16 v19, v145, v5, v19
  v_dot2_f32_bf16 v19, v146, v6, v19
  v_dot2_f32_bf16 v19, v147, v7, v19
  v_dot2_f32_bf16 v19, v148, v8, v19
  v_dot2_f32_bf16 v19, v149, v9, v19
  v_dot2_f32_bf16 v19, v150, v10, v19
  v_dot2_f32_bf16 v19, v151, v11, v19
  v_dot2_f32_bf16 v19, v152, v12, v19
  v_dot2_f32_bf16 v19, v153, v13, v19
  v_dot2_f32_bf16 v19, v154, v14, v19
  v_dot2_f32_bf16 v19, v155, v15, v19
  s_nop 2
  v_add_f32_dpp v19, v19, v19 quad_perm:[1,0,3,2] row_mask:0xf bank_mask:0xf
  s_nop 1
  v_add_f32_dpp v19, v19, v19 quad_perm:[2,3,0,1] row_mask:0xf bank_mask:0xf
  s_nop 1
  v_add_f32_dpp v19, v19, v19 row_half_mirror row_mask:0xf bank_mask:0xf
  s_mov_b32 s64, 184320
  buffer_load_dwordx4 v[144:147], v1, s[24:27], s64 offen offset:0 nt
  buffer_load_dwordx4 v[148:151], v1, s[24:27], s64 offen offset:128 nt
  buffer_load_dwordx4 v[152:155], v1, s[24:27], s64 offen offset:256 nt
  s_waitcnt vmcnt(33)
  v_dot2_f32_bf16 v20, v156, v4, 0
  v_dot2_f32_bf16 v20, v157, v5, v20
  v_dot2_f32_bf16 v20, v158, v6, v20
  v_dot2_f32_bf16 v20, v159, v7, v20
  v_dot2_f32_bf16 v20, v160, v8, v20
  v_dot2_f32_bf16 v20, v161, v9, v20
  v_dot2_f32_bf16 v20, v162, v10, v20
  v_dot2_f32_bf16 v20, v163, v11, v20
  v_dot2_f32_bf16 v20, v164, v12, v20
  v_dot2_f32_bf16 v20, v165, v13, v20
  v_dot2_f32_bf16 v20, v166, v14, v20
  v_dot2_f32_bf16 v20, v167, v15, v20
  s_nop 2
  v_add_f32_dpp v20, v20, v20 quad_perm:[1,0,3,2] row_mask:0xf bank_mask:0xf
  s_nop 1
  v_add_f32_dpp v20, v20, v20 quad_perm:[2,3,0,1] row_mask:0xf bank_mask:0xf
  s_nop 1
  v_add_f32_dpp v20, v20, v20 row_half_mirror row_mask:0xf bank_mask:0xf
  s_mov_b32 s64, 196608
  buffer_load_dwordx4 v[156:159], v1, s[24:27], s64 offen offset:0 nt
  buffer_load_dwordx4 v[160:163], v1, s[24:27], s64 offen offset:128 nt
  buffer_load_dwordx4 v[164:167], v1, s[24:27], s64 offen offset:256 nt
  s_waitcnt vmcnt(33)
  v_dot2_f32_bf16 v21, v168, v4, 0
  v_dot2_f32_bf16 v21, v169, v5, v21
  v_dot2_f32_bf16 v21, v170, v6, v21
  v_dot2_f32_bf16 v21, v171, v7, v21
  v_dot2_f32_bf16 v21, v172, v8, v21
  v_dot2_f32_bf16 v21, v173, v9, v21
  v_dot2_f32_bf16 v21, v174, v10, v21
  v_dot2_f32_bf16 v21, v175, v11, v21
  v_dot2_f32_bf16 v21, v176, v12, v21
  v_dot2_f32_bf16 v21, v177, v13, v21
  v_dot2_f32_bf16 v21, v178, v14, v21
  v_dot2_f32_bf16 v21, v179, v15, v21
  s_nop 2
  v_add_f32_dpp v21, v21, v21 quad_perm:[1,0,3,2] row_mask:0xf bank_mask:0xf
  s_nop 1
  v_add_f32_dpp v21, v21, v21 quad_perm:[2,3,0,1] row_mask:0xf bank_mask:0xf
  s_nop 1
  v_add_f32_dpp v21, v21, v21 row_half_mirror row_mask:0xf bank_mask:0xf
  s_mov_b32 s64, 208896
  buffer_load_dwordx4 v[168:171], v1, s[24:27], s64 offen offset:0 nt
  buffer_load_dwordx4 v[172:175], v1, s[24:27], s64 offen offset:128 nt
  buffer_load_dwordx4 v[176:179], v1, s[24:27], s64 offen offset:256 nt
  s_waitcnt vmcnt(33)
  v_dot2_f32_bf16 v22, v180, v4, 0
  v_dot2_f32_bf16 v22, v181, v5, v22
  v_dot2_f32_bf16 v22, v182, v6, v22
  v_dot2_f32_bf16 v22, v183, v7, v22
  v_dot2_f32_bf16 v22, v184, v8, v22
  v_dot2_f32_bf16 v22, v185, v9, v22
  v_dot2_f32_bf16 v22, v186, v10, v22
  v_dot2_f32_bf16 v22, v187, v11, v22
  v_dot2_f32_bf16 v22, v188, v12, v22
  v_dot2_f32_bf16 v22, v189, v13, v22
  v_dot2_f32_bf16 v22, v190, v14, v22
  v_dot2_f32_bf16 v22, v191, v15, v22
  s_nop 2
  v_add_f32_dpp v22, v22, v22 quad_perm:[1,0,3,2] row_mask:0xf bank_mask:0xf
  s_nop 1
  v_add_f32_dpp v22, v22, v22 quad_perm:[2,3,0,1] row_mask:0xf bank_mask:0xf
  s_nop 1
  v_add_f32_dpp v22, v22, v22 row_half_mirror row_mask:0xf bank_mask:0xf
  s_mov_b32 s64, 221184
  buffer_load_dwordx4 v[180:183], v1, s[24:27], s64 offen offset:0 nt
  buffer_load_dwordx4 v[184:187], v1, s[24:27], s64 offen offset:128 nt
  buffer_load_dwordx4 v[188:191], v1, s[24:27], s64 offen offset:256 nt
  s_waitcnt vmcnt(33)
  v_dot2_f32_bf16 v23, v192, v4, 0
  v_dot2_f32_bf16 v23, v193, v5, v23
  v_dot2_f32_bf16 v23, v194, v6, v23
  v_dot2_f32_bf16 v23, v195, v7, v23
  v_dot2_f32_bf16 v23, v196, v8, v23
  v_dot2_f32_bf16 v23, v197, v9, v23
  v_dot2_f32_bf16 v23, v198, v10, v23
  v_dot2_f32_bf16 v23, v199, v11, v23
  v_dot2_f32_bf16 v23, v200, v12, v23
  v_dot2_f32_bf16 v23, v201, v13, v23
  v_dot2_f32_bf16 v23, v202, v14, v23
  v_dot2_f32_bf16 v23, v203, v15, v23
  s_nop 2
  v_add_f32_dpp v23, v23, v23 quad_perm:[1,0,3,2] row_mask:0xf bank_mask:0xf
  s_nop 1
  v_add_f32_dpp v23, v23, v23 quad_perm:[2,3,0,1] row_mask:0xf bank_mask:0xf
  s_nop 1
  v_add_f32_dpp v23, v23, v23 row_half_mirror row_mask:0xf bank_mask:0xf
  s_mov_b32 s64, 233472
  buffer_load_dwordx4 v[192:195], v1, s[24:27], s64 offen offset:0 nt
  buffer_load_dwordx4 v[196:199], v1, s[24:27], s64 offen offset:128 nt
  buffer_load_dwordx4 v[200:203], v1, s[24:27], s64 offen offset:256 nt
  s_waitcnt vmcnt(33)
  v_dot2_f32_bf16 v24, v204, v4, 0
  v_dot2_f32_bf16 v24, v205, v5, v24
  v_dot2_f32_bf16 v24, v206, v6, v24
  v_dot2_f32_bf16 v24, v207, v7, v24
  v_dot2_f32_bf16 v24, v208, v8, v24
  v_dot2_f32_bf16 v24, v209, v9, v24
  v_dot2_f32_bf16 v24, v210, v10, v24
  v_dot2_f32_bf16 v24, v211, v11, v24
  v_dot2_f32_bf16 v24, v212, v12, v24
  v_dot2_f32_bf16 v24, v213, v13, v24
  v_dot2_f32_bf16 v24, v214, v14, v24
  v_dot2_f32_bf16 v24, v215, v15, v24
  s_nop 2
  v_add_f32_dpp v24, v24, v24 quad_perm:[1,0,3,2] row_mask:0xf bank_mask:0xf
  s_nop 1
  v_add_f32_dpp v24, v24, v24 quad_perm:[2,3,0,1] row_mask:0xf bank_mask:0xf
  s_nop 1
  v_add_f32_dpp v24, v24, v24 row_half_mirror row_mask:0xf bank_mask:0xf
  s_mov_b32 s64, 245760
  buffer_load_dwordx4 v[204:207], v1, s[24:27], s64 offen offset:0 nt
  buffer_load_dwordx4 v[208:211], v1, s[24:27], s64 offen offset:128 nt
  buffer_load_dwordx4 v[212:215], v1, s[24:27], s64 offen offset:256 nt
  s_waitcnt vmcnt(33)
  v_dot2_f32_bf16 v25, v216, v4, 0
  v_dot2_f32_bf16 v25, v217, v5, v25
  v_dot2_f32_bf16 v25, v218, v6, v25
  v_dot2_f32_bf16 v25, v219, v7, v25
  v_dot2_f32_bf16 v25, v220, v8, v25
  v_dot2_f32_bf16 v25, v221, v9, v25
  v_dot2_f32_bf16 v25, v222, v10, v25
  v_dot2_f32_bf16 v25, v223, v11, v25
  v_dot2_f32_bf16 v25, v224, v12, v25
  v_dot2_f32_bf16 v25, v225, v13, v25
  v_dot2_f32_bf16 v25, v226, v14, v25
  v_dot2_f32_bf16 v25, v227, v15, v25
  s_nop 2
  v_add_f32_dpp v25, v25, v25 quad_perm:[1,0,3,2] row_mask:0xf bank_mask:0xf
  s_nop 1
  v_add_f32_dpp v25, v25, v25 quad_perm:[2,3,0,1] row_mask:0xf bank_mask:0xf
  s_nop 1
  v_add_f32_dpp v25, v25, v25 row_half_mirror row_mask:0xf bank_mask:0xf
  s_mov_b32 s64, 258048
  buffer_load_dwordx4 v[216:219], v1, s[24:27], s64 offen offset:0 nt
  buffer_load_dwordx4 v[220:223], v1, s[24:27], s64 offen offset:128 nt
  buffer_load_dwordx4 v[224:227], v1, s[24:27], s64 offen offset:256 nt
  s_waitcnt vmcnt(33)
  v_dot2_f32_bf16 v26, v228, v4, 0
  v_dot2_f32_bf16 v26, v229, v5, v26
  v_dot2_f32_bf16 v26, v230, v6, v26
  v_dot2_f32_bf16 v26, v231, v7, v26
  v_dot2_f32_bf16 v26, v232, v8, v26
  v_dot2_f32_bf16 v26, v233, v9, v26
  v_dot2_f32_bf16 v26, v234, v10, v26
  v_dot2_f32_bf16 v26, v235, v11, v26
  v_dot2_f32_bf16 v26, v236, v12, v26
  v_dot2_f32_bf16 v26, v237, v13, v26
  v_dot2_f32_bf16 v26, v238, v14, v26
  v_dot2_f32_bf16 v26, v239, v15, v26
  s_nop 2
  v_add_f32_dpp v26, v26, v26 quad_perm:[1,0,3,2] row_mask:0xf bank_mask:0xf
  s_nop 1
  v_add_f32_dpp v26, v26, v26 quad_perm:[2,3,0,1] row_mask:0xf bank_mask:0xf
  s_nop 1
  v_add_f32_dpp v26, v26, v26 row_half_mirror row_mask:0xf bank_mask:0xf
  s_mov_b32 s64, 270336
  buffer_load_dwordx4 v[228:231], v1, s[24:27], s64 offen offset:0 nt
  buffer_load_dwordx4 v[232:235], v1, s[24:27], s64 offen offset:128 nt
  buffer_load_dwordx4 v[236:239], v1, s[24:27], s64 offen offset:256 nt
  s_waitcnt vmcnt(33)
  v_dot2_f32_bf16 v27, v240, v4, 0
  v_dot2_f32_bf16 v27, v241, v5, v27
  v_dot2_f32_bf16 v27, v242, v6, v27
  v_dot2_f32_bf16 v27, v243, v7, v27
  v_dot2_f32_bf16 v27, v244, v8, v27
  v_dot2_f32_bf16 v27, v245, v9, v27
  v_dot2_f32_bf16 v27, v246, v10, v27
  v_dot2_f32_bf16 v27, v247, v11, v27
  v_dot2_f32_bf16 v27, v248, v12, v27
  v_dot2_f32_bf16 v27, v249, v13, v27
  v_dot2_f32_bf16 v27, v250, v14, v27
  v_dot2_f32_bf16 v27, v251, v15, v27
  s_nop 2
  v_add_f32_dpp v27, v27, v27 quad_perm:[1,0,3,2] row_mask:0xf bank_mask:0xf
  s_nop 1
  v_add_f32_dpp v27, v27, v27 quad_perm:[2,3,0,1] row_mask:0xf bank_mask:0xf
  s_nop 1
  v_add_f32_dpp v27, v27, v27 row_half_mirror row_mask:0xf bank_mask:0xf
  s_mov_b32 s64, 282624
  buffer_load_dwordx4 v[240:243], v1, s[24:27], s64 offen offset:0 nt
  buffer_load_dwordx4 v[244:247], v1, s[24:27], s64 offen offset:128 nt
  buffer_load_dwordx4 v[248:251], v1, s[24:27], s64 offen offset:256 nt
  s_waitcnt vmcnt(33)
  v_dot2_f32_bf16 v28, v108, v4, 0
  v_dot2_f32_bf16 v28, v109, v5, v28
  v_dot2_f32_bf16 v28, v110, v6, v28
  v_dot2_f32_bf16 v28, v111, v7, v28
  v_dot2_f32_bf16 v28, v112, v8, v28
  v_dot2_f32_bf16 v28, v113, v9, v28
  v_dot2_f32_bf16 v28, v114, v10, v28
  v_dot2_f32_bf16 v28, v115, v11, v28
  v_dot2_f32_bf16 v28, v116, v12, v28
  v_dot2_f32_bf16 v28, v117, v13, v28
  v_dot2_f32_bf16 v28, v118, v14, v28
  v_dot2_f32_bf16 v28, v119, v15, v28
  s_nop 2
  v_add_f32_dpp v28, v28, v28 quad_perm:[1,0,3,2] row_mask:0xf bank_mask:0xf
  s_nop 1
  v_add_f32_dpp v28, v28, v28 quad_perm:[2,3,0,1] row_mask:0xf bank_mask:0xf
  s_nop 1
  v_add_f32_dpp v28, v28, v28 row_half_mirror row_mask:0xf bank_mask:0xf
  s_mov_b32 s64, 294912
  buffer_load_dwordx4 v[108:111], v1, s[24:27], s64 offen offset:0 nt
  buffer_load_dwordx4 v[112:115], v1, s[24:27], s64 offen offset:128 nt
  buffer_load_dwordx4 v[116:119], v1, s[24:27], s64 offen offset:256 nt
  s_waitcnt vmcnt(33)
  v_dot2_f32_bf16 v29, v120, v4, 0
  v_dot2_f32_bf16 v29, v121, v5, v29
  v_dot2_f32_bf16 v29, v122, v6, v29
  v_dot2_f32_bf16 v29, v123, v7, v29
  v_dot2_f32_bf16 v29, v124, v8, v29
  v_dot2_f32_bf16 v29, v125, v9, v29
  v_dot2_f32_bf16 v29, v126, v10, v29
  v_dot2_f32_bf16 v29, v127, v11, v29
  v_dot2_f32_bf16 v29, v128, v12, v29
  v_dot2_f32_bf16 v29, v129, v13, v29
  v_dot2_f32_bf16 v29, v130, v14, v29
  v_dot2_f32_bf16 v29, v131, v15, v29
  s_nop 2
  v_add_f32_dpp v29, v29, v29 quad_perm:[1,0,3,2] row_mask:0xf bank_mask:0xf
  s_nop 1
  v_add_f32_dpp v29, v29, v29 quad_perm:[2,3,0,1] row_mask:0xf bank_mask:0xf
  s_nop 1
  v_add_f32_dpp v29, v29, v29 row_half_mirror row_mask:0xf bank_mask:0xf
  s_mov_b32 s64, 307200
  buffer_load_dwordx4 v[120:123], v1, s[24:27], s64 offen offset:0 nt
  buffer_load_dwordx4 v[124:127], v1, s[24:27], s64 offen offset:128 nt
  buffer_load_dwordx4 v[128:131], v1, s[24:27], s64 offen offset:256 nt
  s_waitcnt vmcnt(33)
  v_dot2_f32_bf16 v30, v132, v4, 0
  v_dot2_f32_bf16 v30, v133, v5, v30
  v_dot2_f32_bf16 v30, v134, v6, v30
  v_dot2_f32_bf16 v30, v135, v7, v30
  v_dot2_f32_bf16 v30, v136, v8, v30
  v_dot2_f32_bf16 v30, v137, v9, v30
  v_dot2_f32_bf16 v30, v138, v10, v30
  v_dot2_f32_bf16 v30, v139, v11, v30
  v_dot2_f32_bf16 v30, v140, v12, v30
  v_dot2_f32_bf16 v30, v141, v13, v30
  v_dot2_f32_bf16 v30, v142, v14, v30
  v_dot2_f32_bf16 v30, v143, v15, v30
  s_nop 2
  v_add_f32_dpp v30, v30, v30 quad_perm:[1,0,3,2] row_mask:0xf bank_mask:0xf
  s_nop 1
  v_add_f32_dpp v30, v30, v30 quad_perm:[2,3,0,1] row_mask:0xf bank_mask:0xf
  s_nop 1
  v_add_f32_dpp v30, v30, v30 row_half_mirror row_mask:0xf bank_mask:0xf
  s_mov_b32 s64, 319488
  buffer_load_dwordx4 v[132:135], v1, s[24:27], s64 offen offset:0 nt
  buffer_load_dwordx4 v[136:139], v1, s[24:27], s64 offen offset:128 nt
  buffer_load_dwordx4 v[140:143], v1, s[24:27], s64 offen offset:256 nt
  s_waitcnt vmcnt(33)
  v_dot2_f32_bf16 v31, v144, v4, 0
  v_dot2_f32_bf16 v31, v145, v5, v31
  v_dot2_f32_bf16 v31, v146, v6, v31
  v_dot2_f32_bf16 v31, v147, v7, v31
  v_dot2_f32_bf16 v31, v148, v8, v31
  v_dot2_f32_bf16 v31, v149, v9, v31
  v_dot2_f32_bf16 v31, v150, v10, v31
  v_dot2_f32_bf16 v31, v151, v11, v31
  v_dot2_f32_bf16 v31, v152, v12, v31
  v_dot2_f32_bf16 v31, v153, v13, v31
  v_dot2_f32_bf16 v31, v154, v14, v31
  v_dot2_f32_bf16 v31, v155, v15, v31
  s_nop 2
  v_add_f32_dpp v31, v31, v31 quad_perm:[1,0,3,2] row_mask:0xf bank_mask:0xf
  s_nop 1
  v_add_f32_dpp v31, v31, v31 quad_perm:[2,3,0,1] row_mask:0xf bank_mask:0xf
  s_nop 1
  v_add_f32_dpp v31, v31, v31 row_half_mirror row_mask:0xf bank_mask:0xf
  s_mov_b32 s64, 331776
  buffer_load_dwordx4 v[144:147], v1, s[24:27], s64 offen offset:0 nt
  buffer_load_dwordx4 v[148:151], v1, s[24:27], s64 offen offset:128 nt
  buffer_load_dwordx4 v[152:155], v1, s[24:27], s64 offen offset:256 nt
  s_waitcnt vmcnt(33)
  v_dot2_f32_bf16 v32, v156, v4, 0
  v_dot2_f32_bf16 v32, v157, v5, v32
  v_dot2_f32_bf16 v32, v158, v6, v32
  v_dot2_f32_bf16 v32, v159, v7, v32
  v_dot2_f32_bf16 v32, v160, v8, v32
  v_dot2_f32_bf16 v32, v161, v9, v32
  v_dot2_f32_bf16 v32, v162, v10, v32
  v_dot2_f32_bf16 v32, v163, v11, v32
  v_dot2_f32_bf16 v32, v164, v12, v32
  v_dot2_f32_bf16 v32, v165, v13, v32
  v_dot2_f32_bf16 v32, v166, v14, v32
  v_dot2_f32_bf16 v32, v167, v15, v32
  s_nop 2
  v_add_f32_dpp v32, v32, v32 quad_perm:[1,0,3,2] row_mask:0xf bank_mask:0xf
  s_nop 1
  v_add_f32_dpp v32, v32, v32 quad_perm:[2,3,0,1] row_mask:0xf bank_mask:0xf
  s_nop 1
  v_add_f32_dpp v32, v32, v32 row_half_mirror row_mask:0xf bank_mask:0xf
  s_mov_b32 s64, 344064
  buffer_load_dwordx4 v[156:159], v1, s[24:27], s64 offen offset:0 nt
  buffer_load_dwordx4 v[160:163], v1, s[24:27], s64 offen offset:128 nt
  buffer_load_dwordx4 v[164:167], v1, s[24:27], s64 offen offset:256 nt
  s_waitcnt vmcnt(33)
  v_dot2_f32_bf16 v33, v168, v4, 0
  v_dot2_f32_bf16 v33, v169, v5, v33
  v_dot2_f32_bf16 v33, v170, v6, v33
  v_dot2_f32_bf16 v33, v171, v7, v33
  v_dot2_f32_bf16 v33, v172, v8, v33
  v_dot2_f32_bf16 v33, v173, v9, v33
  v_dot2_f32_bf16 v33, v174, v10, v33
  v_dot2_f32_bf16 v33, v175, v11, v33
  v_dot2_f32_bf16 v33, v176, v12, v33
  v_dot2_f32_bf16 v33, v177, v13, v33
  v_dot2_f32_bf16 v33, v178, v14, v33
  v_dot2_f32_bf16 v33, v179, v15, v33
  s_nop 2
  v_add_f32_dpp v33, v33, v33 quad_perm:[1,0,3,2] row_mask:0xf bank_mask:0xf
  s_nop 1
  v_add_f32_dpp v33, v33, v33 quad_perm:[2,3,0,1] row_mask:0xf bank_mask:0xf
  s_nop 1
  v_add_f32_dpp v33, v33, v33 row_half_mirror row_mask:0xf bank_mask:0xf
  s_mov_b32 s64, 356352
  buffer_load_dwordx4 v[168:171], v1, s[24:27], s64 offen offset:0 nt
  buffer_load_dwordx4 v[172:175], v1, s[24:27], s64 offen offset:128 nt
  buffer_load_dwordx4 v[176:179], v1, s[24:27], s64 offen offset:256 nt
  s_waitcnt vmcnt(33)
  v_dot2_f32_bf16 v34, v180, v4, 0
  v_dot2_f32_bf16 v34, v181, v5, v34
  v_dot2_f32_bf16 v34, v182, v6, v34
  v_dot2_f32_bf16 v34, v183, v7, v34
  v_dot2_f32_bf16 v34, v184, v8, v34
  v_dot2_f32_bf16 v34, v185, v9, v34
  v_dot2_f32_bf16 v34, v186, v10, v34
  v_dot2_f32_bf16 v34, v187, v11, v34
  v_dot2_f32_bf16 v34, v188, v12, v34
  v_dot2_f32_bf16 v34, v189, v13, v34
  v_dot2_f32_bf16 v34, v190, v14, v34
  v_dot2_f32_bf16 v34, v191, v15, v34
  s_nop 2
  v_add_f32_dpp v34, v34, v34 quad_perm:[1,0,3,2] row_mask:0xf bank_mask:0xf
  s_nop 1
  v_add_f32_dpp v34, v34, v34 quad_perm:[2,3,0,1] row_mask:0xf bank_mask:0xf
  s_nop 1
  v_add_f32_dpp v34, v34, v34 row_half_mirror row_mask:0xf bank_mask:0xf
  s_mov_b32 s64, 368640
  buffer_load_dwordx4 v[180:183], v1, s[24:27], s64 offen offset:0 nt
  buffer_load_dwordx4 v[184:187], v1, s[24:27], s64 offen offset:128 nt
  buffer_load_dwordx4 v[188:191], v1, s[24:27], s64 offen offset:256 nt
  s_waitcnt vmcnt(33)
  v_dot2_f32_bf16 v35, v192, v4, 0
  v_dot2_f32_bf16 v35, v193, v5, v35
  v_dot2_f32_bf16 v35, v194, v6, v35
  v_dot2_f32_bf16 v35, v195, v7, v35
  v_dot2_f32_bf16 v35, v196, v8, v35
  v_dot2_f32_bf16 v35, v197, v9, v35
  v_dot2_f32_bf16 v35, v198, v10, v35
  v_dot2_f32_bf16 v35, v199, v11, v35
  v_dot2_f32_bf16 v35, v200, v12, v35
  v_dot2_f32_bf16 v35, v201, v13, v35
  v_dot2_f32_bf16 v35, v202, v14, v35
  v_dot2_f32_bf16 v35, v203, v15, v35
  s_nop 2
  v_add_f32_dpp v35, v35, v35 quad_perm:[1,0,3,2] row_mask:0xf bank_mask:0xf
  s_nop 1
  v_add_f32_dpp v35, v35, v35 quad_perm:[2,3,0,1] row_mask:0xf bank_mask:0xf
  s_nop 1
  v_add_f32_dpp v35, v35, v35 row_half_mirror row_mask:0xf bank_mask:0xf
  s_mov_b32 s64, 380928
  buffer_load_dwordx4 v[192:195], v1, s[24:27], s64 offen offset:0 nt
  buffer_load_dwordx4 v[196:199], v1, s[24:27], s64 offen offset:128 nt
  buffer_load_dwordx4 v[200:203], v1, s[24:27], s64 offen offset:256 nt
  s_waitcnt vmcnt(33)
  v_dot2_f32_bf16 v36, v204, v4, 0
  v_dot2_f32_bf16 v36, v205, v5, v36
  v_dot2_f32_bf16 v36, v206, v6, v36
  v_dot2_f32_bf16 v36, v207, v7, v36
  v_dot2_f32_bf16 v36, v208, v8, v36
  v_dot2_f32_bf16 v36, v209, v9, v36
  v_dot2_f32_bf16 v36, v210, v10, v36
  v_dot2_f32_bf16 v36, v211, v11, v36
  v_dot2_f32_bf16 v36, v212, v12, v36
  v_dot2_f32_bf16 v36, v213, v13, v36
  v_dot2_f32_bf16 v36, v214, v14, v36
  v_dot2_f32_bf16 v36, v215, v15, v36
  s_nop 2
  v_add_f32_dpp v36, v36, v36 quad_perm:[1,0,3,2] row_mask:0xf bank_mask:0xf
  s_nop 1
  v_add_f32_dpp v36, v36, v36 quad_perm:[2,3,0,1] row_mask:0xf bank_mask:0xf
  s_nop 1
  v_add_f32_dpp v36, v36, v36 row_half_mirror row_mask:0xf bank_mask:0xf
  buffer_load_dwordx4 v[204:207], v1, s[28:31], 0 offen offset:0 nt
  buffer_load_dwordx4 v[208:211], v1, s[28:31], 0 offen offset:128 nt
  buffer_load_dwordx4 v[212:215], v1, s[28:31], 0 offen offset:256 nt
  s_waitcnt vmcnt(33)
  v_dot2_f32_bf16 v37, v216, v4, 0
  v_dot2_f32_bf16 v37, v217, v5, v37
  v_dot2_f32_bf16 v37, v218, v6, v37
  v_dot2_f32_bf16 v37, v219, v7, v37
  v_dot2_f32_bf16 v37, v220, v8, v37
  v_dot2_f32_bf16 v37, v221, v9, v37
  v_dot2_f32_bf16 v37, v222, v10, v37
  v_dot2_f32_bf16 v37, v223, v11, v37
  v_dot2_f32_bf16 v37, v224, v12, v37
  v_dot2_f32_bf16 v37, v225, v13, v37
  v_dot2_f32_bf16 v37, v226, v14, v37
  v_dot2_f32_bf16 v37, v227, v15, v37
  s_nop 2
  v_add_f32_dpp v37, v37, v37 quad_perm:[1,0,3,2] row_mask:0xf bank_mask:0xf
  s_nop 1
  v_add_f32_dpp v37, v37, v37 quad_perm:[2,3,0,1] row_mask:0xf bank_mask:0xf
  s_nop 1
  v_add_f32_dpp v37, v37, v37 row_half_mirror row_mask:0xf bank_mask:0xf
  s_mov_b32 s64, 12288
  buffer_load_dwordx4 v[216:219], v1, s[28:31], s64 offen offset:0 nt
  buffer_load_dwordx4 v[220:223], v1, s[28:31], s64 offen offset:128 nt
  buffer_load_dwordx4 v[224:227], v1, s[28:31], s64 offen offset:256 nt
  s_waitcnt vmcnt(33)
  v_dot2_f32_bf16 v38, v228, v4, 0
  v_dot2_f32_bf16 v38, v229, v5, v38
  v_dot2_f32_bf16 v38, v230, v6, v38
  v_dot2_f32_bf16 v38, v231, v7, v38
  v_dot2_f32_bf16 v38, v232, v8, v38
  v_dot2_f32_bf16 v38, v233, v9, v38
  v_dot2_f32_bf16 v38, v234, v10, v38
  v_dot2_f32_bf16 v38, v235, v11, v38
  v_dot2_f32_bf16 v38, v236, v12, v38
  v_dot2_f32_bf16 v38, v237, v13, v38
  v_dot2_f32_bf16 v38, v238, v14, v38
  v_dot2_f32_bf16 v38, v239, v15, v38
  s_nop 2
  v_add_f32_dpp v38, v38, v38 quad_perm:[1,0,3,2] row_mask:0xf bank_mask:0xf
  s_nop 1
  v_add_f32_dpp v38, v38, v38 quad_perm:[2,3,0,1] row_mask:0xf bank_mask:0xf
  s_nop 1
  v_add_f32_dpp v38, v38, v38 row_half_mirror row_mask:0xf bank_mask:0xf
  s_mov_b32 s64, 24576
  buffer_load_dwordx4 v[228:231], v1, s[28:31], s64 offen offset:0 nt
  buffer_load_dwordx4 v[232:235], v1, s[28:31], s64 offen offset:128 nt
  buffer_load_dwordx4 v[236:239], v1, s[28:31], s64 offen offset:256 nt
  s_waitcnt vmcnt(33)
  v_dot2_f32_bf16 v39, v240, v4, 0
  v_dot2_f32_bf16 v39, v241, v5, v39
  v_dot2_f32_bf16 v39, v242, v6, v39
  v_dot2_f32_bf16 v39, v243, v7, v39
  v_dot2_f32_bf16 v39, v244, v8, v39
  v_dot2_f32_bf16 v39, v245, v9, v39
  v_dot2_f32_bf16 v39, v246, v10, v39
  v_dot2_f32_bf16 v39, v247, v11, v39
  v_dot2_f32_bf16 v39, v248, v12, v39
  v_dot2_f32_bf16 v39, v249, v13, v39
  v_dot2_f32_bf16 v39, v250, v14, v39
  v_dot2_f32_bf16 v39, v251, v15, v39
  s_nop 2
  v_add_f32_dpp v39, v39, v39 quad_perm:[1,0,3,2] row_mask:0xf bank_mask:0xf
  s_nop 1
  v_add_f32_dpp v39, v39, v39 quad_perm:[2,3,0,1] row_mask:0xf bank_mask:0xf
  s_nop 1
  v_add_f32_dpp v39, v39, v39 row_half_mirror row_mask:0xf bank_mask:0xf
  s_mov_b32 s64, 36864
  buffer_load_dwordx4 v[240:243], v1, s[28:31], s64 offen offset:0 nt
  buffer_load_dwordx4 v[244:247], v1, s[28:31], s64 offen offset:128 nt
  buffer_load_dwordx4 v[248:251], v1, s[28:31], s64 offen offset:256 nt
  s_waitcnt vmcnt(33)
  v_dot2_f32_bf16 v40, v108, v4, 0
  v_dot2_f32_bf16 v40, v109, v5, v40
  v_dot2_f32_bf16 v40, v110, v6, v40
  v_dot2_f32_bf16 v40, v111, v7, v40
  v_dot2_f32_bf16 v40, v112, v8, v40
  v_dot2_f32_bf16 v40, v113, v9, v40
  v_dot2_f32_bf16 v40, v114, v10, v40
  v_dot2_f32_bf16 v40, v115, v11, v40
  v_dot2_f32_bf16 v40, v116, v12, v40
  v_dot2_f32_bf16 v40, v117, v13, v40
  v_dot2_f32_bf16 v40, v118, v14, v40
  v_dot2_f32_bf16 v40, v119, v15, v40
  s_nop 2
  v_add_f32_dpp v40, v40, v40 quad_perm:[1,0,3,2] row_mask:0xf bank_mask:0xf
  s_nop 1
  v_add_f32_dpp v40, v40, v40 quad_perm:[2,3,0,1] row_mask:0xf bank_mask:0xf
  s_nop 1
  v_add_f32_dpp v40, v40, v40 row_half_mirror row_mask:0xf bank_mask:0xf
  s_mov_b32 s64, 49152
  buffer_load_dwordx4 v[108:111], v1, s[28:31], s64 offen offset:0 nt
  buffer_load_dwordx4 v[112:115], v1, s[28:31], s64 offen offset:128 nt
  buffer_load_dwordx4 v[116:119], v1, s[28:31], s64 offen offset:256 nt
  s_waitcnt vmcnt(33)
  v_dot2_f32_bf16 v41, v120, v4, 0
  v_dot2_f32_bf16 v41, v121, v5, v41
  v_dot2_f32_bf16 v41, v122, v6, v41
  v_dot2_f32_bf16 v41, v123, v7, v41
  v_dot2_f32_bf16 v41, v124, v8, v41
  v_dot2_f32_bf16 v41, v125, v9, v41
  v_dot2_f32_bf16 v41, v126, v10, v41
  v_dot2_f32_bf16 v41, v127, v11, v41
  v_dot2_f32_bf16 v41, v128, v12, v41
  v_dot2_f32_bf16 v41, v129, v13, v41
  v_dot2_f32_bf16 v41, v130, v14, v41
  v_dot2_f32_bf16 v41, v131, v15, v41
  s_nop 2
  v_add_f32_dpp v41, v41, v41 quad_perm:[1,0,3,2] row_mask:0xf bank_mask:0xf
  s_nop 1
  v_add_f32_dpp v41, v41, v41 quad_perm:[2,3,0,1] row_mask:0xf bank_mask:0xf
  s_nop 1
  v_add_f32_dpp v41, v41, v41 row_half_mirror row_mask:0xf bank_mask:0xf
  s_mov_b32 s64, 61440
  buffer_load_dwordx4 v[120:123], v1, s[28:31], s64 offen offset:0 nt
  buffer_load_dwordx4 v[124:127], v1, s[28:31], s64 offen offset:128 nt
  buffer_load_dwordx4 v[128:131], v1, s[28:31], s64 offen offset:256 nt
  s_waitcnt vmcnt(33)
  v_dot2_f32_bf16 v42, v132, v4, 0
  v_dot2_f32_bf16 v42, v133, v5, v42
  v_dot2_f32_bf16 v42, v134, v6, v42
  v_dot2_f32_bf16 v42, v135, v7, v42
  v_dot2_f32_bf16 v42, v136, v8, v42
  v_dot2_f32_bf16 v42, v137, v9, v42
  v_dot2_f32_bf16 v42, v138, v10, v42
  v_dot2_f32_bf16 v42, v139, v11, v42
  v_dot2_f32_bf16 v42, v140, v12, v42
  v_dot2_f32_bf16 v42, v141, v13, v42
  v_dot2_f32_bf16 v42, v142, v14, v42
  v_dot2_f32_bf16 v42, v143, v15, v42
  s_nop 2
  v_add_f32_dpp v42, v42, v42 quad_perm:[1,0,3,2] row_mask:0xf bank_mask:0xf
  s_nop 1
  v_add_f32_dpp v42, v42, v42 quad_perm:[2,3,0,1] row_mask:0xf bank_mask:0xf
  s_nop 1
  v_add_f32_dpp v42, v42, v42 row_half_mirror row_mask:0xf bank_mask:0xf
  s_mov_b32 s64, 73728
  buffer_load_dwordx4 v[132:135], v1, s[28:31], s64 offen offset:0 nt
  buffer_load_dwordx4 v[136:139], v1, s[28:31], s64 offen offset:128 nt
  buffer_load_dwordx4 v[140:143], v1, s[28:31], s64 offen offset:256 nt
  s_waitcnt vmcnt(33)
  v_dot2_f32_bf16 v43, v144, v4, 0
  v_dot2_f32_bf16 v43, v145, v5, v43
  v_dot2_f32_bf16 v43, v146, v6, v43
  v_dot2_f32_bf16 v43, v147, v7, v43
  v_dot2_f32_bf16 v43, v148, v8, v43
  v_dot2_f32_bf16 v43, v149, v9, v43
  v_dot2_f32_bf16 v43, v150, v10, v43
  v_dot2_f32_bf16 v43, v151, v11, v43
  v_dot2_f32_bf16 v43, v152, v12, v43
  v_dot2_f32_bf16 v43, v153, v13, v43
  v_dot2_f32_bf16 v43, v154, v14, v43
  v_dot2_f32_bf16 v43, v155, v15, v43
  s_nop 2
  v_add_f32_dpp v43, v43, v43 quad_perm:[1,0,3,2] row_mask:0xf bank_mask:0xf
  s_nop 1
  v_add_f32_dpp v43, v43, v43 quad_perm:[2,3,0,1] row_mask:0xf bank_mask:0xf
  s_nop 1
  v_add_f32_dpp v43, v43, v43 row_half_mirror row_mask:0xf bank_mask:0xf
  s_mov_b32 s64, 86016
  buffer_load_dwordx4 v[144:147], v1, s[28:31], s64 offen offset:0 nt
  buffer_load_dwordx4 v[148:151], v1, s[28:31], s64 offen offset:128 nt
  buffer_load_dwordx4 v[152:155], v1, s[28:31], s64 offen offset:256 nt
  s_waitcnt vmcnt(33)
  v_dot2_f32_bf16 v44, v156, v4, 0
  v_dot2_f32_bf16 v44, v157, v5, v44
  v_dot2_f32_bf16 v44, v158, v6, v44
  v_dot2_f32_bf16 v44, v159, v7, v44
  v_dot2_f32_bf16 v44, v160, v8, v44
  v_dot2_f32_bf16 v44, v161, v9, v44
  v_dot2_f32_bf16 v44, v162, v10, v44
  v_dot2_f32_bf16 v44, v163, v11, v44
  v_dot2_f32_bf16 v44, v164, v12, v44
  v_dot2_f32_bf16 v44, v165, v13, v44
  v_dot2_f32_bf16 v44, v166, v14, v44
  v_dot2_f32_bf16 v44, v167, v15, v44
  s_nop 2
  v_add_f32_dpp v44, v44, v44 quad_perm:[1,0,3,2] row_mask:0xf bank_mask:0xf
  s_nop 1
  v_add_f32_dpp v44, v44, v44 quad_perm:[2,3,0,1] row_mask:0xf bank_mask:0xf
  s_nop 1
  v_add_f32_dpp v44, v44, v44 row_half_mirror row_mask:0xf bank_mask:0xf
  s_mov_b32 s64, 98304
  buffer_load_dwordx4 v[156:159], v1, s[28:31], s64 offen offset:0 nt
  buffer_load_dwordx4 v[160:163], v1, s[28:31], s64 offen offset:128 nt
  buffer_load_dwordx4 v[164:167], v1, s[28:31], s64 offen offset:256 nt
  s_waitcnt vmcnt(33)
  v_dot2_f32_bf16 v45, v168, v4, 0
  v_dot2_f32_bf16 v45, v169, v5, v45
  v_dot2_f32_bf16 v45, v170, v6, v45
  v_dot2_f32_bf16 v45, v171, v7, v45
  v_dot2_f32_bf16 v45, v172, v8, v45
  v_dot2_f32_bf16 v45, v173, v9, v45
  v_dot2_f32_bf16 v45, v174, v10, v45
  v_dot2_f32_bf16 v45, v175, v11, v45
  v_dot2_f32_bf16 v45, v176, v12, v45
  v_dot2_f32_bf16 v45, v177, v13, v45
  v_dot2_f32_bf16 v45, v178, v14, v45
  v_dot2_f32_bf16 v45, v179, v15, v45
  s_nop 2
  v_add_f32_dpp v45, v45, v45 quad_perm:[1,0,3,2] row_mask:0xf bank_mask:0xf
  s_nop 1
  v_add_f32_dpp v45, v45, v45 quad_perm:[2,3,0,1] row_mask:0xf bank_mask:0xf
  s_nop 1
  v_add_f32_dpp v45, v45, v45 row_half_mirror row_mask:0xf bank_mask:0xf
  s_mov_b32 s64, 110592
  buffer_load_dwordx4 v[168:171], v1, s[28:31], s64 offen offset:0 nt
  buffer_load_dwordx4 v[172:175], v1, s[28:31], s64 offen offset:128 nt
  buffer_load_dwordx4 v[176:179], v1, s[28:31], s64 offen offset:256 nt
  s_waitcnt vmcnt(33)
  v_dot2_f32_bf16 v46, v180, v4, 0
  v_dot2_f32_bf16 v46, v181, v5, v46
  v_dot2_f32_bf16 v46, v182, v6, v46
  v_dot2_f32_bf16 v46, v183, v7, v46
  v_dot2_f32_bf16 v46, v184, v8, v46
  v_dot2_f32_bf16 v46, v185, v9, v46
  v_dot2_f32_bf16 v46, v186, v10, v46
  v_dot2_f32_bf16 v46, v187, v11, v46
  v_dot2_f32_bf16 v46, v188, v12, v46
  v_dot2_f32_bf16 v46, v189, v13, v46
  v_dot2_f32_bf16 v46, v190, v14, v46
  v_dot2_f32_bf16 v46, v191, v15, v46
  s_nop 2
  v_add_f32_dpp v46, v46, v46 quad_perm:[1,0,3,2] row_mask:0xf bank_mask:0xf
  s_nop 1
  v_add_f32_dpp v46, v46, v46 quad_perm:[2,3,0,1] row_mask:0xf bank_mask:0xf
  s_nop 1
  v_add_f32_dpp v46, v46, v46 row_half_mirror row_mask:0xf bank_mask:0xf
  s_mov_b32 s64, 122880
  buffer_load_dwordx4 v[180:183], v1, s[28:31], s64 offen offset:0 nt
  buffer_load_dwordx4 v[184:187], v1, s[28:31], s64 offen offset:128 nt
  buffer_load_dwordx4 v[188:191], v1, s[28:31], s64 offen offset:256 nt
  s_waitcnt vmcnt(33)
  v_dot2_f32_bf16 v47, v192, v4, 0
  v_dot2_f32_bf16 v47, v193, v5, v47
  v_dot2_f32_bf16 v47, v194, v6, v47
  v_dot2_f32_bf16 v47, v195, v7, v47
  v_dot2_f32_bf16 v47, v196, v8, v47
  v_dot2_f32_bf16 v47, v197, v9, v47
  v_dot2_f32_bf16 v47, v198, v10, v47
  v_dot2_f32_bf16 v47, v199, v11, v47
  v_dot2_f32_bf16 v47, v200, v12, v47
  v_dot2_f32_bf16 v47, v201, v13, v47
  v_dot2_f32_bf16 v47, v202, v14, v47
  v_dot2_f32_bf16 v47, v203, v15, v47
  s_nop 2
  v_add_f32_dpp v47, v47, v47 quad_perm:[1,0,3,2] row_mask:0xf bank_mask:0xf
  s_nop 1
  v_add_f32_dpp v47, v47, v47 quad_perm:[2,3,0,1] row_mask:0xf bank_mask:0xf
  s_nop 1
  v_add_f32_dpp v47, v47, v47 row_half_mirror row_mask:0xf bank_mask:0xf
  s_mov_b32 s64, 135168
  buffer_load_dwordx4 v[192:195], v1, s[28:31], s64 offen offset:0 nt
  buffer_load_dwordx4 v[196:199], v1, s[28:31], s64 offen offset:128 nt
  buffer_load_dwordx4 v[200:203], v1, s[28:31], s64 offen offset:256 nt
  buffer_load_dwordx4 v[72:75], v2, s[36:39], 0 offen offset:0
  buffer_load_dwordx4 v[76:79], v2, s[36:39], 0 offen offset:128
  buffer_load_dwordx4 v[80:83], v2, s[36:39], 0 offen offset:256
  buffer_load_ushort v84, v88, s[40:43], 0 offen
  buffer_load_ushort v85, v89, s[40:43], 0 offen
  buffer_load_ushort v86, v90, s[40:43], 0 offen
  buffer_load_ushort v87, off, s[44:47], 0
  s_waitcnt vmcnt(40)
  v_max_f32 v92, v16, v17
  v_max3_f32 v92, v92, v18, v19
  v_max3_f32 v92, v92, v20, v21
  v_max3_f32 v92, v92, v22, v23
  v_max3_f32 v92, v92, v24, v25
  v_max3_f32 v92, v92, v26, v27
  v_max3_f32 v92, v92, v28, v29
  v_max3_f32 v92, v92, v30, v31
  v_max3_f32 v92, v92, v32, v33
  v_max3_f32 v92, v92, v34, v35
  v_max3_f32 v92, v92, v36, v37
  v_max3_f32 v92, v92, v38, v39
  v_max3_f32 v92, v92, v40, v41
  v_max3_f32 v92, v92, v42, v43
  v_max3_f32 v92, v92, v44, v45
  v_max3_f32 v92, v92, v46, v47
  s_nop 1
  v_max_f32_dpp v92, v92, v92 row_ror:8 row_mask:0xf bank_mask:0xf
  v_mov_b32 v93, v92
  s_nop 1
  v_permlane16_swap_b32 v92, v93
  s_nop 1
  v_max_f32 v92, v92, v93
  v_mov_b32 v93, v92
  s_nop 1
  v_permlane32_swap_b32 v92, v93
  s_nop 1
  v_max_f32 v92, v92, v93
  s_mov_b32 s65, 0x3dd53b95
  v_mul_f32 v92, s65, v92
  v_fma_f32 v16, v16, s65, -v92
  v_fma_f32 v17, v17, s65, -v92
  v_fma_f32 v18, v18, s65, -v92
  v_fma_f32 v19, v19, s65, -v92
  v_fma_f32 v20, v20, s65, -v92
  v_fma_f32 v21, v21, s65, -v92
  v_fma_f32 v22, v22, s65, -v92
  v_fma_f32 v23, v23, s65, -v92
  v_fma_f32 v24, v24, s65, -v92
  v_fma_f32 v25, v25, s65, -v92
  v_fma_f32 v26, v26, s65, -v92
  v_fma_f32 v27, v27, s65, -v92
  v_fma_f32 v28, v28, s65, -v92
  v_fma_f32 v29, v29, s65, -v92
  v_fma_f32 v30, v30, s65, -v92
  v_fma_f32 v31, v31, s65, -v92
  v_fma_f32 v32, v32, s65, -v92
  v_fma_f32 v33, v33, s65, -v92
  v_fma_f32 v34, v34, s65, -v92
  v_fma_f32 v35, v35, s65, -v92
  v_fma_f32 v36, v36, s65, -v92
  v_fma_f32 v37, v37, s65, -v92
  v_fma_f32 v38, v38, s65, -v92
  v_fma_f32 v39, v39, s65, -v92
  v_fma_f32 v40, v40, s65, -v92
  v_fma_f32 v41, v41, s65, -v92
  v_fma_f32 v42, v42, s65, -v92
  v_fma_f32 v43, v43, s65, -v92
  v_fma_f32 v44, v44, s65, -v92
  v_fma_f32 v45, v45, s65, -v92
  v_fma_f32 v46, v46, s65, -v92
  v_fma_f32 v47, v47, s65, -v92
  v_exp_f32 v16, v16
  v_exp_f32 v17, v17
  v_exp_f32 v18, v18
  v_exp_f32 v19, v19
  v_exp_f32 v20, v20
  v_exp_f32 v21, v21
  v_exp_f32 v22, v22
  v_exp_f32 v23, v23
  v_exp_f32 v24, v24
  v_exp_f32 v25, v25
  v_exp_f32 v26, v26
  v_exp_f32 v27, v27
  v_exp_f32 v28, v28
  v_exp_f32 v29, v29
  v_exp_f32 v30, v30
  v_exp_f32 v31, v31
  v_exp_f32 v32, v32
  v_exp_f32 v33, v33
  v_exp_f32 v34, v34
  v_exp_f32 v35, v35
  v_exp_f32 v36, v36
  v_exp_f32 v37, v37
  v_exp_f32 v38, v38
  v_exp_f32 v39, v39
  v_exp_f32 v40, v40
  v_exp_f32 v41, v41
  v_exp_f32 v42, v42
  v_exp_f32 v43, v43
  v_exp_f32 v44, v44
  v_exp_f32 v45, v45
  v_exp_f32 v46, v46
  v_exp_f32 v47, v47
  s_nop 0
  v_add_f32 v94, v16, v17
  v_add_f32 v94, v94, v18
  v_add_f32 v94, v94, v19
  v_add_f32 v94, v94, v20
  v_add_f32 v94, v94, v21
  v_add_f32 v94, v94, v22
  v_add_f32 v94, v94, v23
  v_add_f32 v94, v94, v24
  v_add_f32 v94, v94, v25
  v_add_f32 v94, v94, v26
  v_add_f32 v94, v94, v27
  v_add_f32 v94, v94, v28
  v_add_f32 v94, v94, v29
  v_add_f32 v94, v94, v30
  v_add_f32 v94, v94, v31
  v_add_f32 v94, v94, v32
  v_add_f32 v94, v94, v33
  v_add_f32 v94, v94, v34
  v_add_f32 v94, v94, v35
  v_add_f32 v94, v94, v36
  v_add_f32 v94, v94, v37
  v_add_f32 v94, v94, v38
  v_add_f32 v94, v94, v39
  v_add_f32 v94, v94, v40
  v_add_f32 v94, v94, v41
  v_add_f32 v94, v94, v42
  v_add_f32 v94, v94, v43
  v_add_f32 v94, v94, v44
  v_add_f32 v94, v94, v45
  v_add_f32 v94, v94, v46
  v_add_f32 v94, v94, v47
  s_nop 1
  v_add_f32_dpp v94, v94, v94 row_ror:8 row_mask:0xf bank_mask:0xf
  v_mov_b32 v93, v94
  s_nop 1
  v_permlane16_swap_b32 v94, v93
  s_nop 1
  v_add_f32 v94, v94, v93
  v_mov_b32 v93, v94
  s_nop 1
  v_permlane32_swap_b32 v94, v93
  s_nop 1
  v_add_f32 v94, v94, v93
  v_rcp_f32 v93, v94
  v_log_f32 v94, v94
  s_nop 0
  v_mul_f32 v16, v16, v93
  v_mul_f32 v17, v17, v93
  v_mul_f32 v18, v18, v93
  v_mul_f32 v19, v19, v93
  v_mul_f32 v20, v20, v93
  v_mul_f32 v21, v21, v93
  v_mul_f32 v22, v22, v93
  v_mul_f32 v23, v23, v93
  v_mul_f32 v24, v24, v93
  v_mul_f32 v25, v25, v93
  v_mul_f32 v26, v26, v93
  v_mul_f32 v27, v27, v93
  v_mul_f32 v28, v28, v93
  v_mul_f32 v29, v29, v93
  v_mul_f32 v30, v30, v93
  v_mul_f32 v31, v31, v93
  v_mul_f32 v32, v32, v93
  v_mul_f32 v33, v33, v93
  v_mul_f32 v34, v34, v93
  v_mul_f32 v35, v35, v93
  v_mul_f32 v36, v36, v93
  v_mul_f32 v37, v37, v93
  v_mul_f32 v38, v38, v93
  v_mul_f32 v39, v39, v93
  v_mul_f32 v40, v40, v93
  v_mul_f32 v41, v41, v93
  v_mul_f32 v42, v42, v93
  v_mul_f32 v43, v43, v93
  v_mul_f32 v44, v44, v93
  v_mul_f32 v45, v45, v93
  v_mul_f32 v46, v46, v93
  v_mul_f32 v47, v47, v93
  v_add_f32 v104, v94, v92
  v_lshlrev_b32 v96, 16, v204
  v_and_b32 v97, s67, v204
  v_pk_mul_f32 v[48:49], v[96:97], v[16:17] op_sel_hi:[1,0]
  v_lshlrev_b32 v98, 16, v205
  v_and_b32 v99, s67, v205
  v_pk_mul_f32 v[50:51], v[98:99], v[16:17] op_sel_hi:[1,0]
  v_lshlrev_b32 v100, 16, v206
  v_and_b32 v101, s67, v206
  v_pk_mul_f32 v[52:53], v[100:101], v[16:17] op_sel_hi:[1,0]
  v_lshlrev_b32 v102, 16, v207
  v_and_b32 v103, s67, v207
  v_pk_mul_f32 v[54:55], v[102:103], v[16:17] op_sel_hi:[1,0]
  v_lshlrev_b32 v96, 16, v208
  v_and_b32 v97, s67, v208
  v_pk_mul_f32 v[56:57], v[96:97], v[16:17] op_sel_hi:[1,0]
  v_lshlrev_b32 v98, 16, v209
  v_and_b32 v99, s67, v209
  v_pk_mul_f32 v[58:59], v[98:99], v[16:17] op_sel_hi:[1,0]
  v_lshlrev_b32 v100, 16, v210
  v_and_b32 v101, s67, v210
  v_pk_mul_f32 v[60:61], v[100:101], v[16:17] op_sel_hi:[1,0]
  v_lshlrev_b32 v102, 16, v211
  v_and_b32 v103, s67, v211
  v_pk_mul_f32 v[62:63], v[102:103], v[16:17] op_sel_hi:[1,0]
  v_lshlrev_b32 v96, 16, v212
  v_and_b32 v97, s67, v212
  v_pk_mul_f32 v[64:65], v[96:97], v[16:17] op_sel_hi:[1,0]
  v_lshlrev_b32 v98, 16, v213
  v_and_b32 v99, s67, v213
  v_pk_mul_f32 v[66:67], v[98:99], v[16:17] op_sel_hi:[1,0]
  v_lshlrev_b32 v100, 16, v214
  v_and_b32 v101, s67, v214
  v_pk_mul_f32 v[68:69], v[100:101], v[16:17] op_sel_hi:[1,0]
  v_lshlrev_b32 v102, 16, v215
  v_and_b32 v103, s67, v215
  v_pk_mul_f32 v[70:71], v[102:103], v[16:17] op_sel_hi:[1,0]
  s_mov_b32 s64, 147456
  buffer_load_dwordx4 v[204:207], v1, s[28:31], s64 offen offset:0 nt
  buffer_load_dwordx4 v[208:211], v1, s[28:31], s64 offen offset:128 nt
  buffer_load_dwordx4 v[212:215], v1, s[28:31], s64 offen offset:256 nt
  s_waitcnt vmcnt(40)
  v_lshlrev_b32 v96, 16, v216
  v_and_b32 v97, s67, v216
  v_pk_fma_f32 v[48:49], v[96:97], v[16:17], v[48:49] op_sel:[0,1,0] op_sel_hi:[1,1,1]
  v_lshlrev_b32 v98, 16, v217
  v_and_b32 v99, s67, v217
  v_pk_fma_f32 v[50:51], v[98:99], v[16:17], v[50:51] op_sel:[0,1,0] op_sel_hi:[1,1,1]
  v_lshlrev_b32 v100, 16, v218
  v_and_b32 v101, s67, v218
  v_pk_fma_f32 v[52:53], v[100:101], v[16:17], v[52:53] op_sel:[0,1,0] op_sel_hi:[1,1,1]
  v_lshlrev_b32 v102, 16, v219
  v_and_b32 v103, s67, v219
  v_pk_fma_f32 v[54:55], v[102:103], v[16:17], v[54:55] op_sel:[0,1,0] op_sel_hi:[1,1,1]
  v_lshlrev_b32 v96, 16, v220
  v_and_b32 v97, s67, v220
  v_pk_fma_f32 v[56:57], v[96:97], v[16:17], v[56:57] op_sel:[0,1,0] op_sel_hi:[1,1,1]
  v_lshlrev_b32 v98, 16, v221
  v_and_b32 v99, s67, v221
  v_pk_fma_f32 v[58:59], v[98:99], v[16:17], v[58:59] op_sel:[0,1,0] op_sel_hi:[1,1,1]
  v_lshlrev_b32 v100, 16, v222
  v_and_b32 v101, s67, v222
  v_pk_fma_f32 v[60:61], v[100:101], v[16:17], v[60:61] op_sel:[0,1,0] op_sel_hi:[1,1,1]
  v_lshlrev_b32 v102, 16, v223
  v_and_b32 v103, s67, v223
  v_pk_fma_f32 v[62:63], v[102:103], v[16:17], v[62:63] op_sel:[0,1,0] op_sel_hi:[1,1,1]
  v_lshlrev_b32 v96, 16, v224
  v_and_b32 v97, s67, v224
  v_pk_fma_f32 v[64:65], v[96:97], v[16:17], v[64:65] op_sel:[0,1,0] op_sel_hi:[1,1,1]
  v_lshlrev_b32 v98, 16, v225
  v_and_b32 v99, s67, v225
  v_pk_fma_f32 v[66:67], v[98:99], v[16:17], v[66:67] op_sel:[0,1,0] op_sel_hi:[1,1,1]
  v_lshlrev_b32 v100, 16, v226
  v_and_b32 v101, s67, v226
  v_pk_fma_f32 v[68:69], v[100:101], v[16:17], v[68:69] op_sel:[0,1,0] op_sel_hi:[1,1,1]
  v_lshlrev_b32 v102, 16, v227
  v_and_b32 v103, s67, v227
  v_pk_fma_f32 v[70:71], v[102:103], v[16:17], v[70:71] op_sel:[0,1,0] op_sel_hi:[1,1,1]
  s_mov_b32 s64, 159744
  buffer_load_dwordx4 v[216:219], v1, s[28:31], s64 offen offset:0 nt
  buffer_load_dwordx4 v[220:223], v1, s[28:31], s64 offen offset:128 nt
  buffer_load_dwordx4 v[224:227], v1, s[28:31], s64 offen offset:256 nt
  s_waitcnt vmcnt(40)
  v_lshlrev_b32 v96, 16, v228
  v_and_b32 v97, s67, v228
  v_pk_fma_f32 v[48:49], v[96:97], v[18:19], v[48:49] op_sel_hi:[1,0,1]
  v_lshlrev_b32 v98, 16, v229
  v_and_b32 v99, s67, v229
  v_pk_fma_f32 v[50:51], v[98:99], v[18:19], v[50:51] op_sel_hi:[1,0,1]
  v_lshlrev_b32 v100, 16, v230
  v_and_b32 v101, s67, v230
  v_pk_fma_f32 v[52:53], v[100:101], v[18:19], v[52:53] op_sel_hi:[1,0,1]
  v_lshlrev_b32 v102, 16, v231
  v_and_b32 v103, s67, v231
  v_pk_fma_f32 v[54:55], v[102:103], v[18:19], v[54:55] op_sel_hi:[1,0,1]
  v_lshlrev_b32 v96, 16, v232
  v_and_b32 v97, s67, v232
  v_pk_fma_f32 v[56:57], v[96:97], v[18:19], v[56:57] op_sel_hi:[1,0,1]
  v_lshlrev_b32 v98, 16, v233
  v_and_b32 v99, s67, v233
  v_pk_fma_f32 v[58:59], v[98:99], v[18:19], v[58:59] op_sel_hi:[1,0,1]
  v_lshlrev_b32 v100, 16, v234
  v_and_b32 v101, s67, v234
  v_pk_fma_f32 v[60:61], v[100:101], v[18:19], v[60:61] op_sel_hi:[1,0,1]
  v_lshlrev_b32 v102, 16, v235
  v_and_b32 v103, s67, v235
  v_pk_fma_f32 v[62:63], v[102:103], v[18:19], v[62:63] op_sel_hi:[1,0,1]
  v_lshlrev_b32 v96, 16, v236
  v_and_b32 v97, s67, v236
  v_pk_fma_f32 v[64:65], v[96:97], v[18:19], v[64:65] op_sel_hi:[1,0,1]
  v_lshlrev_b32 v98, 16, v237
  v_and_b32 v99, s67, v237
  v_pk_fma_f32 v[66:67], v[98:99], v[18:19], v[66:67] op_sel_hi:[1,0,1]
  v_lshlrev_b32 v100, 16, v238
  v_and_b32 v101, s67, v238
  v_pk_fma_f32 v[68:69], v[100:101], v[18:19], v[68:69] op_sel_hi:[1,0,1]
  v_lshlrev_b32 v102, 16, v239
  v_and_b32 v103, s67, v239
  v_pk_fma_f32 v[70:71], v[102:103], v[18:19], v[70:71] op_sel_hi:[1,0,1]
  s_mov_b32 s64, 172032
  buffer_load_dwordx4 v[228:231], v1, s[28:31], s64 offen offset:0 nt
  buffer_load_dwordx4 v[232:235], v1, s[28:31], s64 offen offset:128 nt
  buffer_load_dwordx4 v[236:239], v1, s[28:31], s64 offen offset:256 nt
  s_mov_b32 s56, s18
  s_mov_b32 s57, s19
  s_mov_b32 s58, 256
  s_mov_b32 s59, 0x20000
  s_lshl_b32 s63, s60, 3
  s_add_u32 s86, s61, 0
  s_and_b32 s86, s86, 7
  s_lshl_b32 s86, s86, 10
  s_add_u32 s87, s61, 1
  s_and_b32 s87, s87, 7
  s_lshl_b32 s87, s87, 10
  s_add_u32 s88, s61, 2
  s_and_b32 s88, s88, 7
  s_lshl_b32 s88, s88, 10
  s_add_u32 s89, s61, 3
  s_and_b32 s89, s89, 7
  s_lshl_b32 s89, s89, 10
  s_add_u32 s90, s61, 4
  s_and_b32 s90, s90, 7
  s_lshl_b32 s90, s90, 10
  s_add_u32 s91, s61, 5
  s_and_b32 s91, s91, 7
  s_lshl_b32 s91, s91, 10
  s_add_u32 s92, s61, 6
  s_and_b32 s92, s92, 7
  s_lshl_b32 s92, s92, 10
  s_add_u32 s93, s61, 7
  s_and_b32 s93, s93, 7
  s_lshl_b32 s93, s93, 10
  v_and_b32 v107, 63, v0
  v_lshlrev_b32 v107, 4, v107
  s_waitcnt vmcnt(40)
  v_lshlrev_b32 v96, 16, v240
  v_and_b32 v97, s67, v240
  v_pk_fma_f32 v[48:49], v[96:97], v[18:19], v[48:49] op_sel:[0,1,0] op_sel_hi:[1,1,1]
  v_lshlrev_b32 v98, 16, v241
  v_and_b32 v99, s67, v241
  v_pk_fma_f32 v[50:51], v[98:99], v[18:19], v[50:51] op_sel:[0,1,0] op_sel_hi:[1,1,1]
  v_lshlrev_b32 v100, 16, v242
  v_and_b32 v101, s67, v242
  v_pk_fma_f32 v[52:53], v[100:101], v[18:19], v[52:53] op_sel:[0,1,0] op_sel_hi:[1,1,1]
  v_lshlrev_b32 v102, 16, v243
  v_and_b32 v103, s67, v243
  v_pk_fma_f32 v[54:55], v[102:103], v[18:19], v[54:55] op_sel:[0,1,0] op_sel_hi:[1,1,1]
  v_lshlrev_b32 v96, 16, v244
  v_and_b32 v97, s67, v244
  v_pk_fma_f32 v[56:57], v[96:97], v[18:19], v[56:57] op_sel:[0,1,0] op_sel_hi:[1,1,1]
  v_lshlrev_b32 v98, 16, v245
  v_and_b32 v99, s67, v245
  v_pk_fma_f32 v[58:59], v[98:99], v[18:19], v[58:59] op_sel:[0,1,0] op_sel_hi:[1,1,1]
  v_lshlrev_b32 v100, 16, v246
  v_and_b32 v101, s67, v246
  v_pk_fma_f32 v[60:61], v[100:101], v[18:19], v[60:61] op_sel:[0,1,0] op_sel_hi:[1,1,1]
  v_lshlrev_b32 v102, 16, v247
  v_and_b32 v103, s67, v247
  v_pk_fma_f32 v[62:63], v[102:103], v[18:19], v[62:63] op_sel:[0,1,0] op_sel_hi:[1,1,1]
  v_lshlrev_b32 v96, 16, v248
  v_and_b32 v97, s67, v248
  v_pk_fma_f32 v[64:65], v[96:97], v[18:19], v[64:65] op_sel:[0,1,0] op_sel_hi:[1,1,1]
  v_lshlrev_b32 v98, 16, v249
  v_and_b32 v99, s67, v249
  v_pk_fma_f32 v[66:67], v[98:99], v[18:19], v[66:67] op_sel:[0,1,0] op_sel_hi:[1,1,1]
  v_lshlrev_b32 v100, 16, v250
  v_and_b32 v101, s67, v250
  v_pk_fma_f32 v[68:69], v[100:101], v[18:19], v[68:69] op_sel:[0,1,0] op_sel_hi:[1,1,1]
  v_lshlrev_b32 v102, 16, v251
  v_and_b32 v103, s67, v251
  v_pk_fma_f32 v[70:71], v[102:103], v[18:19], v[70:71] op_sel:[0,1,0] op_sel_hi:[1,1,1]
  s_mov_b32 s64, 184320
  buffer_load_dwordx4 v[240:243], v1, s[28:31], s64 offen offset:0 nt
  buffer_load_dwordx4 v[244:247], v1, s[28:31], s64 offen offset:128 nt
  buffer_load_dwordx4 v[248:251], v1, s[28:31], s64 offen offset:256 nt
  s_waitcnt vmcnt(40)
  v_lshlrev_b32 v96, 16, v108
  v_and_b32 v97, s67, v108
  v_pk_fma_f32 v[48:49], v[96:97], v[20:21], v[48:49] op_sel_hi:[1,0,1]
  v_lshlrev_b32 v98, 16, v109
  v_and_b32 v99, s67, v109
  v_pk_fma_f32 v[50:51], v[98:99], v[20:21], v[50:51] op_sel_hi:[1,0,1]
  v_lshlrev_b32 v100, 16, v110
  v_and_b32 v101, s67, v110
  v_pk_fma_f32 v[52:53], v[100:101], v[20:21], v[52:53] op_sel_hi:[1,0,1]
  v_lshlrev_b32 v102, 16, v111
  v_and_b32 v103, s67, v111
  v_pk_fma_f32 v[54:55], v[102:103], v[20:21], v[54:55] op_sel_hi:[1,0,1]
  v_lshlrev_b32 v96, 16, v112
  v_and_b32 v97, s67, v112
  v_pk_fma_f32 v[56:57], v[96:97], v[20:21], v[56:57] op_sel_hi:[1,0,1]
  v_lshlrev_b32 v98, 16, v113
  v_and_b32 v99, s67, v113
  v_pk_fma_f32 v[58:59], v[98:99], v[20:21], v[58:59] op_sel_hi:[1,0,1]
  v_lshlrev_b32 v100, 16, v114
  v_and_b32 v101, s67, v114
  v_pk_fma_f32 v[60:61], v[100:101], v[20:21], v[60:61] op_sel_hi:[1,0,1]
  v_lshlrev_b32 v102, 16, v115
  v_and_b32 v103, s67, v115
  v_pk_fma_f32 v[62:63], v[102:103], v[20:21], v[62:63] op_sel_hi:[1,0,1]
  v_lshlrev_b32 v96, 16, v116
  v_and_b32 v97, s67, v116
  v_pk_fma_f32 v[64:65], v[96:97], v[20:21], v[64:65] op_sel_hi:[1,0,1]
  v_lshlrev_b32 v98, 16, v117
  v_and_b32 v99, s67, v117
  v_pk_fma_f32 v[66:67], v[98:99], v[20:21], v[66:67] op_sel_hi:[1,0,1]
  v_lshlrev_b32 v100, 16, v118
  v_and_b32 v101, s67, v118
  v_pk_fma_f32 v[68:69], v[100:101], v[20:21], v[68:69] op_sel_hi:[1,0,1]
  v_lshlrev_b32 v102, 16, v119
  v_and_b32 v103, s67, v119
  v_pk_fma_f32 v[70:71], v[102:103], v[20:21], v[70:71] op_sel_hi:[1,0,1]
  s_mov_b32 s64, 196608
  buffer_load_dwordx4 v[108:111], v1, s[28:31], s64 offen offset:0 nt
  buffer_load_dwordx4 v[112:115], v1, s[28:31], s64 offen offset:128 nt
  buffer_load_dwordx4 v[116:119], v1, s[28:31], s64 offen offset:256 nt
  s_waitcnt vmcnt(40)
  v_lshlrev_b32 v96, 16, v120
  v_and_b32 v97, s67, v120
  v_pk_fma_f32 v[48:49], v[96:97], v[20:21], v[48:49] op_sel:[0,1,0] op_sel_hi:[1,1,1]
  v_lshlrev_b32 v98, 16, v121
  v_and_b32 v99, s67, v121
  v_pk_fma_f32 v[50:51], v[98:99], v[20:21], v[50:51] op_sel:[0,1,0] op_sel_hi:[1,1,1]
  v_lshlrev_b32 v100, 16, v122
  v_and_b32 v101, s67, v122
  v_pk_fma_f32 v[52:53], v[100:101], v[20:21], v[52:53] op_sel:[0,1,0] op_sel_hi:[1,1,1]
  v_lshlrev_b32 v102, 16, v123
  v_and_b32 v103, s67, v123
  v_pk_fma_f32 v[54:55], v[102:103], v[20:21], v[54:55] op_sel:[0,1,0] op_sel_hi:[1,1,1]
  v_lshlrev_b32 v96, 16, v124
  v_and_b32 v97, s67, v124
  v_pk_fma_f32 v[56:57], v[96:97], v[20:21], v[56:57] op_sel:[0,1,0] op_sel_hi:[1,1,1]
  v_lshlrev_b32 v98, 16, v125
  v_and_b32 v99, s67, v125
  v_pk_fma_f32 v[58:59], v[98:99], v[20:21], v[58:59] op_sel:[0,1,0] op_sel_hi:[1,1,1]
  v_lshlrev_b32 v100, 16, v126
  v_and_b32 v101, s67, v126
  v_pk_fma_f32 v[60:61], v[100:101], v[20:21], v[60:61] op_sel:[0,1,0] op_sel_hi:[1,1,1]
  v_lshlrev_b32 v102, 16, v127
  v_and_b32 v103, s67, v127
  v_pk_fma_f32 v[62:63], v[102:103], v[20:21], v[62:63] op_sel:[0,1,0] op_sel_hi:[1,1,1]
  v_lshlrev_b32 v96, 16, v128
  v_and_b32 v97, s67, v128
  v_pk_fma_f32 v[64:65], v[96:97], v[20:21], v[64:65] op_sel:[0,1,0] op_sel_hi:[1,1,1]
  v_lshlrev_b32 v98, 16, v129
  v_and_b32 v99, s67, v129
  v_pk_fma_f32 v[66:67], v[98:99], v[20:21], v[66:67] op_sel:[0,1,0] op_sel_hi:[1,1,1]
  v_lshlrev_b32 v100, 16, v130
  v_and_b32 v101, s67, v130
  v_pk_fma_f32 v[68:69], v[100:101], v[20:21], v[68:69] op_sel:[0,1,0] op_sel_hi:[1,1,1]
  v_lshlrev_b32 v102, 16, v131
  v_and_b32 v103, s67, v131
  v_pk_fma_f32 v[70:71], v[102:103], v[20:21], v[70:71] op_sel:[0,1,0] op_sel_hi:[1,1,1]
  s_mov_b32 s64, 208896
  buffer_load_dwordx4 v[120:123], v1, s[28:31], s64 offen offset:0 nt
  buffer_load_dwordx4 v[124:127], v1, s[28:31], s64 offen offset:128 nt
  buffer_load_dwordx4 v[128:131], v1, s[28:31], s64 offen offset:256 nt
  s_waitcnt vmcnt(40)
  v_lshlrev_b32 v96, 16, v132
  v_and_b32 v97, s67, v132
  v_pk_fma_f32 v[48:49], v[96:97], v[22:23], v[48:49] op_sel_hi:[1,0,1]
  v_lshlrev_b32 v98, 16, v133
  v_and_b32 v99, s67, v133
  v_pk_fma_f32 v[50:51], v[98:99], v[22:23], v[50:51] op_sel_hi:[1,0,1]
  v_lshlrev_b32 v100, 16, v134
  v_and_b32 v101, s67, v134
  v_pk_fma_f32 v[52:53], v[100:101], v[22:23], v[52:53] op_sel_hi:[1,0,1]
  v_lshlrev_b32 v102, 16, v135
  v_and_b32 v103, s67, v135
  v_pk_fma_f32 v[54:55], v[102:103], v[22:23], v[54:55] op_sel_hi:[1,0,1]
  v_lshlrev_b32 v96, 16, v136
  v_and_b32 v97, s67, v136
  v_pk_fma_f32 v[56:57], v[96:97], v[22:23], v[56:57] op_sel_hi:[1,0,1]
  v_lshlrev_b32 v98, 16, v137
  v_and_b32 v99, s67, v137
  v_pk_fma_f32 v[58:59], v[98:99], v[22:23], v[58:59] op_sel_hi:[1,0,1]
  v_lshlrev_b32 v100, 16, v138
  v_and_b32 v101, s67, v138
  v_pk_fma_f32 v[60:61], v[100:101], v[22:23], v[60:61] op_sel_hi:[1,0,1]
  v_lshlrev_b32 v102, 16, v139
  v_and_b32 v103, s67, v139
  v_pk_fma_f32 v[62:63], v[102:103], v[22:23], v[62:63] op_sel_hi:[1,0,1]
  v_lshlrev_b32 v96, 16, v140
  v_and_b32 v97, s67, v140
  v_pk_fma_f32 v[64:65], v[96:97], v[22:23], v[64:65] op_sel_hi:[1,0,1]
  v_lshlrev_b32 v98, 16, v141
  v_and_b32 v99, s67, v141
  v_pk_fma_f32 v[66:67], v[98:99], v[22:23], v[66:67] op_sel_hi:[1,0,1]
  v_lshlrev_b32 v100, 16, v142
  v_and_b32 v101, s67, v142
  v_pk_fma_f32 v[68:69], v[100:101], v[22:23], v[68:69] op_sel_hi:[1,0,1]
  v_lshlrev_b32 v102, 16, v143
  v_and_b32 v103, s67, v143
  v_pk_fma_f32 v[70:71], v[102:103], v[22:23], v[70:71] op_sel_hi:[1,0,1]
  s_mov_b32 s64, 221184
  buffer_load_dwordx4 v[132:135], v1, s[28:31], s64 offen offset:0 nt
  buffer_load_dwordx4 v[136:139], v1, s[28:31], s64 offen offset:128 nt
  buffer_load_dwordx4 v[140:143], v1, s[28:31], s64 offen offset:256 nt
  s_waitcnt vmcnt(40)
  v_lshlrev_b32 v96, 16, v144
  v_and_b32 v97, s67, v144
  v_pk_fma_f32 v[48:49], v[96:97], v[22:23], v[48:49] op_sel:[0,1,0] op_sel_hi:[1,1,1]
  v_lshlrev_b32 v98, 16, v145
  v_and_b32 v99, s67, v145
  v_pk_fma_f32 v[50:51], v[98:99], v[22:23], v[50:51] op_sel:[0,1,0] op_sel_hi:[1,1,1]
  v_lshlrev_b32 v100, 16, v146
  v_and_b32 v101, s67, v146
  v_pk_fma_f32 v[52:53], v[100:101], v[22:23], v[52:53] op_sel:[0,1,0] op_sel_hi:[1,1,1]
  v_lshlrev_b32 v102, 16, v147
  v_and_b32 v103, s67, v147
  v_pk_fma_f32 v[54:55], v[102:103], v[22:23], v[54:55] op_sel:[0,1,0] op_sel_hi:[1,1,1]
  v_lshlrev_b32 v96, 16, v148
  v_and_b32 v97, s67, v148
  v_pk_fma_f32 v[56:57], v[96:97], v[22:23], v[56:57] op_sel:[0,1,0] op_sel_hi:[1,1,1]
  v_lshlrev_b32 v98, 16, v149
  v_and_b32 v99, s67, v149
  v_pk_fma_f32 v[58:59], v[98:99], v[22:23], v[58:59] op_sel:[0,1,0] op_sel_hi:[1,1,1]
  v_lshlrev_b32 v100, 16, v150
  v_and_b32 v101, s67, v150
  v_pk_fma_f32 v[60:61], v[100:101], v[22:23], v[60:61] op_sel:[0,1,0] op_sel_hi:[1,1,1]
  v_lshlrev_b32 v102, 16, v151
  v_and_b32 v103, s67, v151
  v_pk_fma_f32 v[62:63], v[102:103], v[22:23], v[62:63] op_sel:[0,1,0] op_sel_hi:[1,1,1]
  v_lshlrev_b32 v96, 16, v152
  v_and_b32 v97, s67, v152
  v_pk_fma_f32 v[64:65], v[96:97], v[22:23], v[64:65] op_sel:[0,1,0] op_sel_hi:[1,1,1]
  v_lshlrev_b32 v98, 16, v153
  v_and_b32 v99, s67, v153
  v_pk_fma_f32 v[66:67], v[98:99], v[22:23], v[66:67] op_sel:[0,1,0] op_sel_hi:[1,1,1]
  v_lshlrev_b32 v100, 16, v154
  v_and_b32 v101, s67, v154
  v_pk_fma_f32 v[68:69], v[100:101], v[22:23], v[68:69] op_sel:[0,1,0] op_sel_hi:[1,1,1]
  v_lshlrev_b32 v102, 16, v155
  v_and_b32 v103, s67, v155
  v_pk_fma_f32 v[70:71], v[102:103], v[22:23], v[70:71] op_sel:[0,1,0] op_sel_hi:[1,1,1]
  s_mov_b32 s64, 233472
  buffer_load_dwordx4 v[144:147], v1, s[28:31], s64 offen offset:0 nt
  buffer_load_dwordx4 v[148:151], v1, s[28:31], s64 offen offset:128 nt
  buffer_load_dwordx4 v[152:155], v1, s[28:31], s64 offen offset:256 nt
  s_waitcnt vmcnt(40)
  v_lshlrev_b32 v96, 16, v156
  v_and_b32 v97, s67, v156
  v_pk_fma_f32 v[48:49], v[96:97], v[24:25], v[48:49] op_sel_hi:[1,0,1]
  v_lshlrev_b32 v98, 16, v157
  v_and_b32 v99, s67, v157
  v_pk_fma_f32 v[50:51], v[98:99], v[24:25], v[50:51] op_sel_hi:[1,0,1]
  v_lshlrev_b32 v100, 16, v158
  v_and_b32 v101, s67, v158
  v_pk_fma_f32 v[52:53], v[100:101], v[24:25], v[52:53] op_sel_hi:[1,0,1]
  v_lshlrev_b32 v102, 16, v159
  v_and_b32 v103, s67, v159
  v_pk_fma_f32 v[54:55], v[102:103], v[24:25], v[54:55] op_sel_hi:[1,0,1]
  v_lshlrev_b32 v96, 16, v160
  v_and_b32 v97, s67, v160
  v_pk_fma_f32 v[56:57], v[96:97], v[24:25], v[56:57] op_sel_hi:[1,0,1]
  v_lshlrev_b32 v98, 16, v161
  v_and_b32 v99, s67, v161
  v_pk_fma_f32 v[58:59], v[98:99], v[24:25], v[58:59] op_sel_hi:[1,0,1]
  v_lshlrev_b32 v100, 16, v162
  v_and_b32 v101, s67, v162
  v_pk_fma_f32 v[60:61], v[100:101], v[24:25], v[60:61] op_sel_hi:[1,0,1]
  v_lshlrev_b32 v102, 16, v163
  v_and_b32 v103, s67, v163
  v_pk_fma_f32 v[62:63], v[102:103], v[24:25], v[62:63] op_sel_hi:[1,0,1]
  v_lshlrev_b32 v96, 16, v164
  v_and_b32 v97, s67, v164
  v_pk_fma_f32 v[64:65], v[96:97], v[24:25], v[64:65] op_sel_hi:[1,0,1]
  v_lshlrev_b32 v98, 16, v165
  v_and_b32 v99, s67, v165
  v_pk_fma_f32 v[66:67], v[98:99], v[24:25], v[66:67] op_sel_hi:[1,0,1]
  v_lshlrev_b32 v100, 16, v166
  v_and_b32 v101, s67, v166
  v_pk_fma_f32 v[68:69], v[100:101], v[24:25], v[68:69] op_sel_hi:[1,0,1]
  v_lshlrev_b32 v102, 16, v167
  v_and_b32 v103, s67, v167
  v_pk_fma_f32 v[70:71], v[102:103], v[24:25], v[70:71] op_sel_hi:[1,0,1]
  s_mov_b32 s64, 245760
  buffer_load_dwordx4 v[156:159], v1, s[28:31], s64 offen offset:0 nt
  buffer_load_dwordx4 v[160:163], v1, s[28:31], s64 offen offset:128 nt
  buffer_load_dwordx4 v[164:167], v1, s[28:31], s64 offen offset:256 nt
  s_waitcnt vmcnt(40)
  v_lshlrev_b32 v96, 16, v168
  v_and_b32 v97, s67, v168
  v_pk_fma_f32 v[48:49], v[96:97], v[24:25], v[48:49] op_sel:[0,1,0] op_sel_hi:[1,1,1]
  v_lshlrev_b32 v98, 16, v169
  v_and_b32 v99, s67, v169
  v_pk_fma_f32 v[50:51], v[98:99], v[24:25], v[50:51] op_sel:[0,1,0] op_sel_hi:[1,1,1]
  v_lshlrev_b32 v100, 16, v170
  v_and_b32 v101, s67, v170
  v_pk_fma_f32 v[52:53], v[100:101], v[24:25], v[52:53] op_sel:[0,1,0] op_sel_hi:[1,1,1]
  v_lshlrev_b32 v102, 16, v171
  v_and_b32 v103, s67, v171
  v_pk_fma_f32 v[54:55], v[102:103], v[24:25], v[54:55] op_sel:[0,1,0] op_sel_hi:[1,1,1]
  v_lshlrev_b32 v96, 16, v172
  v_and_b32 v97, s67, v172
  v_pk_fma_f32 v[56:57], v[96:97], v[24:25], v[56:57] op_sel:[0,1,0] op_sel_hi:[1,1,1]
  v_lshlrev_b32 v98, 16, v173
  v_and_b32 v99, s67, v173
  v_pk_fma_f32 v[58:59], v[98:99], v[24:25], v[58:59] op_sel:[0,1,0] op_sel_hi:[1,1,1]
  v_lshlrev_b32 v100, 16, v174
  v_and_b32 v101, s67, v174
  v_pk_fma_f32 v[60:61], v[100:101], v[24:25], v[60:61] op_sel:[0,1,0] op_sel_hi:[1,1,1]
  v_lshlrev_b32 v102, 16, v175
  v_and_b32 v103, s67, v175
  v_pk_fma_f32 v[62:63], v[102:103], v[24:25], v[62:63] op_sel:[0,1,0] op_sel_hi:[1,1,1]
  v_lshlrev_b32 v96, 16, v176
  v_and_b32 v97, s67, v176
  v_pk_fma_f32 v[64:65], v[96:97], v[24:25], v[64:65] op_sel:[0,1,0] op_sel_hi:[1,1,1]
  v_lshlrev_b32 v98, 16, v177
  v_and_b32 v99, s67, v177
  v_pk_fma_f32 v[66:67], v[98:99], v[24:25], v[66:67] op_sel:[0,1,0] op_sel_hi:[1,1,1]
  v_lshlrev_b32 v100, 16, v178
  v_and_b32 v101, s67, v178
  v_pk_fma_f32 v[68:69], v[100:101], v[24:25], v[68:69] op_sel:[0,1,0] op_sel_hi:[1,1,1]
  v_lshlrev_b32 v102, 16, v179
  v_and_b32 v103, s67, v179
  v_pk_fma_f32 v[70:71], v[102:103], v[24:25], v[70:71] op_sel:[0,1,0] op_sel_hi:[1,1,1]
  s_mov_b32 s64, 258048
  buffer_load_dwordx4 v[168:171], v1, s[28:31], s64 offen offset:0 nt
  buffer_load_dwordx4 v[172:175], v1, s[28:31], s64 offen offset:128 nt
  buffer_load_dwordx4 v[176:179], v1, s[28:31], s64 offen offset:256 nt
  s_waitcnt vmcnt(40)
  v_lshlrev_b32 v96, 16, v180
  v_and_b32 v97, s67, v180
  v_pk_fma_f32 v[48:49], v[96:97], v[26:27], v[48:49] op_sel_hi:[1,0,1]
  v_lshlrev_b32 v98, 16, v181
  v_and_b32 v99, s67, v181
  v_pk_fma_f32 v[50:51], v[98:99], v[26:27], v[50:51] op_sel_hi:[1,0,1]
  v_lshlrev_b32 v100, 16, v182
  v_and_b32 v101, s67, v182
  v_pk_fma_f32 v[52:53], v[100:101], v[26:27], v[52:53] op_sel_hi:[1,0,1]
  v_lshlrev_b32 v102, 16, v183
  v_and_b32 v103, s67, v183
  v_pk_fma_f32 v[54:55], v[102:103], v[26:27], v[54:55] op_sel_hi:[1,0,1]
  v_lshlrev_b32 v96, 16, v184
  v_and_b32 v97, s67, v184
  v_pk_fma_f32 v[56:57], v[96:97], v[26:27], v[56:57] op_sel_hi:[1,0,1]
  v_lshlrev_b32 v98, 16, v185
  v_and_b32 v99, s67, v185
  v_pk_fma_f32 v[58:59], v[98:99], v[26:27], v[58:59] op_sel_hi:[1,0,1]
  v_lshlrev_b32 v100, 16, v186
  v_and_b32 v101, s67, v186
  v_pk_fma_f32 v[60:61], v[100:101], v[26:27], v[60:61] op_sel_hi:[1,0,1]
  v_lshlrev_b32 v102, 16, v187
  v_and_b32 v103, s67, v187
  v_pk_fma_f32 v[62:63], v[102:103], v[26:27], v[62:63] op_sel_hi:[1,0,1]
  v_lshlrev_b32 v96, 16, v188
  v_and_b32 v97, s67, v188
  v_pk_fma_f32 v[64:65], v[96:97], v[26:27], v[64:65] op_sel_hi:[1,0,1]
  v_lshlrev_b32 v98, 16, v189
  v_and_b32 v99, s67, v189
  v_pk_fma_f32 v[66:67], v[98:99], v[26:27], v[66:67] op_sel_hi:[1,0,1]
  v_lshlrev_b32 v100, 16, v190
  v_and_b32 v101, s67, v190
  v_pk_fma_f32 v[68:69], v[100:101], v[26:27], v[68:69] op_sel_hi:[1,0,1]
  v_lshlrev_b32 v102, 16, v191
  v_and_b32 v103, s67, v191
  v_pk_fma_f32 v[70:71], v[102:103], v[26:27], v[70:71] op_sel_hi:[1,0,1]
  s_mov_b32 s64, 270336
  buffer_load_dwordx4 v[180:183], v1, s[28:31], s64 offen offset:0 nt
  buffer_load_dwordx4 v[184:187], v1, s[28:31], s64 offen offset:128 nt
  buffer_load_dwordx4 v[188:191], v1, s[28:31], s64 offen offset:256 nt
  s_waitcnt vmcnt(40)
  v_lshlrev_b32 v96, 16, v192
  v_and_b32 v97, s67, v192
  v_pk_fma_f32 v[48:49], v[96:97], v[26:27], v[48:49] op_sel:[0,1,0] op_sel_hi:[1,1,1]
  v_lshlrev_b32 v98, 16, v193
  v_and_b32 v99, s67, v193
  v_pk_fma_f32 v[50:51], v[98:99], v[26:27], v[50:51] op_sel:[0,1,0] op_sel_hi:[1,1,1]
  v_lshlrev_b32 v100, 16, v194
  v_and_b32 v101, s67, v194
  v_pk_fma_f32 v[52:53], v[100:101], v[26:27], v[52:53] op_sel:[0,1,0] op_sel_hi:[1,1,1]
  v_lshlrev_b32 v102, 16, v195
  v_and_b32 v103, s67, v195
  v_pk_fma_f32 v[54:55], v[102:103], v[26:27], v[54:55] op_sel:[0,1,0] op_sel_hi:[1,1,1]
  v_lshlrev_b32 v96, 16, v196
  v_and_b32 v97, s67, v196
  v_pk_fma_f32 v[56:57], v[96:97], v[26:27], v[56:57] op_sel:[0,1,0] op_sel_hi:[1,1,1]
  v_lshlrev_b32 v98, 16, v197
  v_and_b32 v99, s67, v197
  v_pk_fma_f32 v[58:59], v[98:99], v[26:27], v[58:59] op_sel:[0,1,0] op_sel_hi:[1,1,1]
  v_lshlrev_b32 v100, 16, v198
  v_and_b32 v101, s67, v198
  v_pk_fma_f32 v[60:61], v[100:101], v[26:27], v[60:61] op_sel:[0,1,0] op_sel_hi:[1,1,1]
  v_lshlrev_b32 v102, 16, v199
  v_and_b32 v103, s67, v199
  v_pk_fma_f32 v[62:63], v[102:103], v[26:27], v[62:63] op_sel:[0,1,0] op_sel_hi:[1,1,1]
  v_lshlrev_b32 v96, 16, v200
  v_and_b32 v97, s67, v200
  v_pk_fma_f32 v[64:65], v[96:97], v[26:27], v[64:65] op_sel:[0,1,0] op_sel_hi:[1,1,1]
  v_lshlrev_b32 v98, 16, v201
  v_and_b32 v99, s67, v201
  v_pk_fma_f32 v[66:67], v[98:99], v[26:27], v[66:67] op_sel:[0,1,0] op_sel_hi:[1,1,1]
  v_lshlrev_b32 v100, 16, v202
  v_and_b32 v101, s67, v202
  v_pk_fma_f32 v[68:69], v[100:101], v[26:27], v[68:69] op_sel:[0,1,0] op_sel_hi:[1,1,1]
  v_lshlrev_b32 v102, 16, v203
  v_and_b32 v103, s67, v203
  v_pk_fma_f32 v[70:71], v[102:103], v[26:27], v[70:71] op_sel:[0,1,0] op_sel_hi:[1,1,1]
  s_mov_b32 s64, 282624
  buffer_load_dwordx4 v[192:195], v1, s[28:31], s64 offen offset:0 nt
  buffer_load_dwordx4 v[196:199], v1, s[28:31], s64 offen offset:128 nt
  buffer_load_dwordx4 v[200:203], v1, s[28:31], s64 offen offset:256 nt
  s_waitcnt vmcnt(33)
  v_lshlrev_b32 v96, 16, v204
  v_and_b32 v97, s67, v204
  v_pk_fma_f32 v[48:49], v[96:97], v[28:29], v[48:49] op_sel_hi:[1,0,1]
  v_lshlrev_b32 v98, 16, v205
  v_and_b32 v99, s67, v205
  v_pk_fma_f32 v[50:51], v[98:99], v[28:29], v[50:51] op_sel_hi:[1,0,1]
  v_lshlrev_b32 v100, 16, v206
  v_and_b32 v101, s67, v206
  v_pk_fma_f32 v[52:53], v[100:101], v[28:29], v[52:53] op_sel_hi:[1,0,1]
  v_lshlrev_b32 v102, 16, v207
  v_and_b32 v103, s67, v207
  v_pk_fma_f32 v[54:55], v[102:103], v[28:29], v[54:55] op_sel_hi:[1,0,1]
  v_lshlrev_b32 v96, 16, v208
  v_and_b32 v97, s67, v208
  v_pk_fma_f32 v[56:57], v[96:97], v[28:29], v[56:57] op_sel_hi:[1,0,1]
  v_lshlrev_b32 v98, 16, v209
  v_and_b32 v99, s67, v209
  v_pk_fma_f32 v[58:59], v[98:99], v[28:29], v[58:59] op_sel_hi:[1,0,1]
  v_lshlrev_b32 v100, 16, v210
  v_and_b32 v101, s67, v210
  v_pk_fma_f32 v[60:61], v[100:101], v[28:29], v[60:61] op_sel_hi:[1,0,1]
  v_lshlrev_b32 v102, 16, v211
  v_and_b32 v103, s67, v211
  v_pk_fma_f32 v[62:63], v[102:103], v[28:29], v[62:63] op_sel_hi:[1,0,1]
  v_lshlrev_b32 v96, 16, v212
  v_and_b32 v97, s67, v212
  v_pk_fma_f32 v[64:65], v[96:97], v[28:29], v[64:65] op_sel_hi:[1,0,1]
  v_lshlrev_b32 v98, 16, v213
  v_and_b32 v99, s67, v213
  v_pk_fma_f32 v[66:67], v[98:99], v[28:29], v[66:67] op_sel_hi:[1,0,1]
  v_lshlrev_b32 v100, 16, v214
  v_and_b32 v101, s67, v214
  v_pk_fma_f32 v[68:69], v[100:101], v[28:29], v[68:69] op_sel_hi:[1,0,1]
  v_lshlrev_b32 v102, 16, v215
  v_and_b32 v103, s67, v215
  v_pk_fma_f32 v[70:71], v[102:103], v[28:29], v[70:71] op_sel_hi:[1,0,1]
  s_mov_b32 s64, 294912
  buffer_load_dwordx4 v[204:207], v1, s[28:31], s64 offen offset:0 nt
  buffer_load_dwordx4 v[208:211], v1, s[28:31], s64 offen offset:128 nt
  buffer_load_dwordx4 v[212:215], v1, s[28:31], s64 offen offset:256 nt
  s_waitcnt vmcnt(39)
  v_dot2_f32_bf16 v105, v72, v4, 0
  v_dot2_f32_bf16 v105, v73, v5, v105
  v_dot2_f32_bf16 v105, v74, v6, v105
  v_dot2_f32_bf16 v105, v75, v7, v105
  v_dot2_f32_bf16 v105, v76, v8, v105
  v_dot2_f32_bf16 v105, v77, v9, v105
  v_dot2_f32_bf16 v105, v78, v10, v105
  v_dot2_f32_bf16 v105, v79, v11, v105
  v_dot2_f32_bf16 v105, v80, v12, v105
  v_dot2_f32_bf16 v105, v81, v13, v105
  v_dot2_f32_bf16 v105, v82, v14, v105
  v_dot2_f32_bf16 v105, v83, v15, v105
  s_nop 2
  v_add_f32_dpp v105, v105, v105 quad_perm:[1,0,3,2] row_mask:0xf bank_mask:0xf
  s_nop 1
  v_add_f32_dpp v105, v105, v105 quad_perm:[2,3,0,1] row_mask:0xf bank_mask:0xf
  s_nop 1
  v_add_f32_dpp v105, v105, v105 row_half_mirror row_mask:0xf bank_mask:0xf
  v_lshlrev_b32 v84, 16, v84
  v_lshlrev_b32 v85, 16, v85
  v_lshlrev_b32 v86, 16, v86
  v_lshlrev_b32 v87, 16, v87
  v_sub_f32 v87, 1.0, v87
  s_mov_b32 s68, 0xceabfb8f
  v_mul_f32 v87, s68, v87
  v_fma_f32 v87, v105, s65, v87
  s_waitcnt vmcnt(33)
  v_lshlrev_b32 v96, 16, v216
  v_and_b32 v97, s67, v216
  v_pk_fma_f32 v[48:49], v[96:97], v[28:29], v[48:49] op_sel:[0,1,0] op_sel_hi:[1,1,1]
  v_lshlrev_b32 v98, 16, v217
  v_and_b32 v99, s67, v217
  v_pk_fma_f32 v[50:51], v[98:99], v[28:29], v[50:51] op_sel:[0,1,0] op_sel_hi:[1,1,1]
  v_lshlrev_b32 v100, 16, v218
  v_and_b32 v101, s67, v218
  v_pk_fma_f32 v[52:53], v[100:101], v[28:29], v[52:53] op_sel:[0,1,0] op_sel_hi:[1,1,1]
  v_lshlrev_b32 v102, 16, v219
  v_and_b32 v103, s67, v219
  v_pk_fma_f32 v[54:55], v[102:103], v[28:29], v[54:55] op_sel:[0,1,0] op_sel_hi:[1,1,1]
  v_lshlrev_b32 v96, 16, v220
  v_and_b32 v97, s67, v220
  v_pk_fma_f32 v[56:57], v[96:97], v[28:29], v[56:57] op_sel:[0,1,0] op_sel_hi:[1,1,1]
  v_lshlrev_b32 v98, 16, v221
  v_and_b32 v99, s67, v221
  v_pk_fma_f32 v[58:59], v[98:99], v[28:29], v[58:59] op_sel:[0,1,0] op_sel_hi:[1,1,1]
  v_lshlrev_b32 v100, 16, v222
  v_and_b32 v101, s67, v222
  v_pk_fma_f32 v[60:61], v[100:101], v[28:29], v[60:61] op_sel:[0,1,0] op_sel_hi:[1,1,1]
  v_lshlrev_b32 v102, 16, v223
  v_and_b32 v103, s67, v223
  v_pk_fma_f32 v[62:63], v[102:103], v[28:29], v[62:63] op_sel:[0,1,0] op_sel_hi:[1,1,1]
  v_lshlrev_b32 v96, 16, v224
  v_and_b32 v97, s67, v224
  v_pk_fma_f32 v[64:65], v[96:97], v[28:29], v[64:65] op_sel:[0,1,0] op_sel_hi:[1,1,1]
  v_lshlrev_b32 v98, 16, v225
  v_and_b32 v99, s67, v225
  v_pk_fma_f32 v[66:67], v[98:99], v[28:29], v[66:67] op_sel:[0,1,0] op_sel_hi:[1,1,1]
  v_lshlrev_b32 v100, 16, v226
  v_and_b32 v101, s67, v226
  v_pk_fma_f32 v[68:69], v[100:101], v[28:29], v[68:69] op_sel:[0,1,0] op_sel_hi:[1,1,1]
  v_lshlrev_b32 v102, 16, v227
  v_and_b32 v103, s67, v227
  v_pk_fma_f32 v[70:71], v[102:103], v[28:29], v[70:71] op_sel:[0,1,0] op_sel_hi:[1,1,1]
  s_mov_b32 s64, 307200
  buffer_load_dwordx4 v[216:219], v1, s[28:31], s64 offen offset:0 nt
  buffer_load_dwordx4 v[220:223], v1, s[28:31], s64 offen offset:128 nt
  buffer_load_dwordx4 v[224:227], v1, s[28:31], s64 offen offset:256 nt
  s_waitcnt vmcnt(33)
  v_lshlrev_b32 v96, 16, v228
  v_and_b32 v97, s67, v228
  v_pk_fma_f32 v[48:49], v[96:97], v[30:31], v[48:49] op_sel_hi:[1,0,1]
  v_lshlrev_b32 v98, 16, v229
  v_and_b32 v99, s67, v229
  v_pk_fma_f32 v[50:51], v[98:99], v[30:31], v[50:51] op_sel_hi:[1,0,1]
  v_lshlrev_b32 v100, 16, v230
  v_and_b32 v101, s67, v230
  v_pk_fma_f32 v[52:53], v[100:101], v[30:31], v[52:53] op_sel_hi:[1,0,1]
  v_lshlrev_b32 v102, 16, v231
  v_and_b32 v103, s67, v231
  v_pk_fma_f32 v[54:55], v[102:103], v[30:31], v[54:55] op_sel_hi:[1,0,1]
  v_lshlrev_b32 v96, 16, v232
  v_and_b32 v97, s67, v232
  v_pk_fma_f32 v[56:57], v[96:97], v[30:31], v[56:57] op_sel_hi:[1,0,1]
  v_lshlrev_b32 v98, 16, v233
  v_and_b32 v99, s67, v233
  v_pk_fma_f32 v[58:59], v[98:99], v[30:31], v[58:59] op_sel_hi:[1,0,1]
  v_lshlrev_b32 v100, 16, v234
  v_and_b32 v101, s67, v234
  v_pk_fma_f32 v[60:61], v[100:101], v[30:31], v[60:61] op_sel_hi:[1,0,1]
  v_lshlrev_b32 v102, 16, v235
  v_and_b32 v103, s67, v235
  v_pk_fma_f32 v[62:63], v[102:103], v[30:31], v[62:63] op_sel_hi:[1,0,1]
  v_lshlrev_b32 v96, 16, v236
  v_and_b32 v97, s67, v236
  v_pk_fma_f32 v[64:65], v[96:97], v[30:31], v[64:65] op_sel_hi:[1,0,1]
  v_lshlrev_b32 v98, 16, v237
  v_and_b32 v99, s67, v237
  v_pk_fma_f32 v[66:67], v[98:99], v[30:31], v[66:67] op_sel_hi:[1,0,1]
  v_lshlrev_b32 v100, 16, v238
  v_and_b32 v101, s67, v238
  v_pk_fma_f32 v[68:69], v[100:101], v[30:31], v[68:69] op_sel_hi:[1,0,1]
  v_lshlrev_b32 v102, 16, v239
  v_and_b32 v103, s67, v239
  v_pk_fma_f32 v[70:71], v[102:103], v[30:31], v[70:71] op_sel_hi:[1,0,1]
  s_mov_b32 s64, 319488
  buffer_load_dwordx4 v[228:231], v1, s[28:31], s64 offen offset:0 nt
  buffer_load_dwordx4 v[232:235], v1, s[28:31], s64 offen offset:128 nt
  buffer_load_dwordx4 v[236:239], v1, s[28:31], s64 offen offset:256 nt
  s_waitcnt vmcnt(33)
  v_lshlrev_b32 v96, 16, v240
  v_and_b32 v97, s67, v240
  v_pk_fma_f32 v[48:49], v[96:97], v[30:31], v[48:49] op_sel:[0,1,0] op_sel_hi:[1,1,1]
  v_lshlrev_b32 v98, 16, v241
  v_and_b32 v99, s67, v241
  v_pk_fma_f32 v[50:51], v[98:99], v[30:31], v[50:51] op_sel:[0,1,0] op_sel_hi:[1,1,1]
  v_lshlrev_b32 v100, 16, v242
  v_and_b32 v101, s67, v242
  v_pk_fma_f32 v[52:53], v[100:101], v[30:31], v[52:53] op_sel:[0,1,0] op_sel_hi:[1,1,1]
  v_lshlrev_b32 v102, 16, v243
  v_and_b32 v103, s67, v243
  v_pk_fma_f32 v[54:55], v[102:103], v[30:31], v[54:55] op_sel:[0,1,0] op_sel_hi:[1,1,1]
  v_lshlrev_b32 v96, 16, v244
  v_and_b32 v97, s67, v244
  v_pk_fma_f32 v[56:57], v[96:97], v[30:31], v[56:57] op_sel:[0,1,0] op_sel_hi:[1,1,1]
  v_lshlrev_b32 v98, 16, v245
  v_and_b32 v99, s67, v245
  v_pk_fma_f32 v[58:59], v[98:99], v[30:31], v[58:59] op_sel:[0,1,0] op_sel_hi:[1,1,1]
  v_lshlrev_b32 v100, 16, v246
  v_and_b32 v101, s67, v246
  v_pk_fma_f32 v[60:61], v[100:101], v[30:31], v[60:61] op_sel:[0,1,0] op_sel_hi:[1,1,1]
  v_lshlrev_b32 v102, 16, v247
  v_and_b32 v103, s67, v247
  v_pk_fma_f32 v[62:63], v[102:103], v[30:31], v[62:63] op_sel:[0,1,0] op_sel_hi:[1,1,1]
  v_lshlrev_b32 v96, 16, v248
  v_and_b32 v97, s67, v248
  v_pk_fma_f32 v[64:65], v[96:97], v[30:31], v[64:65] op_sel:[0,1,0] op_sel_hi:[1,1,1]
  v_lshlrev_b32 v98, 16, v249
  v_and_b32 v99, s67, v249
  v_pk_fma_f32 v[66:67], v[98:99], v[30:31], v[66:67] op_sel:[0,1,0] op_sel_hi:[1,1,1]
  v_lshlrev_b32 v100, 16, v250
  v_and_b32 v101, s67, v250
  v_pk_fma_f32 v[68:69], v[100:101], v[30:31], v[68:69] op_sel:[0,1,0] op_sel_hi:[1,1,1]
  v_lshlrev_b32 v102, 16, v251
  v_and_b32 v103, s67, v251
  v_pk_fma_f32 v[70:71], v[102:103], v[30:31], v[70:71] op_sel:[0,1,0] op_sel_hi:[1,1,1]
  s_mov_b32 s64, 331776
  buffer_load_dwordx4 v[240:243], v1, s[28:31], s64 offen offset:0 nt
  buffer_load_dwordx4 v[244:247], v1, s[28:31], s64 offen offset:128 nt
  buffer_load_dwordx4 v[248:251], v1, s[28:31], s64 offen offset:256 nt
  s_waitcnt vmcnt(33)
  v_lshlrev_b32 v96, 16, v108
  v_and_b32 v97, s67, v108
  v_pk_fma_f32 v[48:49], v[96:97], v[32:33], v[48:49] op_sel_hi:[1,0,1]
  v_lshlrev_b32 v98, 16, v109
  v_and_b32 v99, s67, v109
  v_pk_fma_f32 v[50:51], v[98:99], v[32:33], v[50:51] op_sel_hi:[1,0,1]
  v_lshlrev_b32 v100, 16, v110
  v_and_b32 v101, s67, v110
  v_pk_fma_f32 v[52:53], v[100:101], v[32:33], v[52:53] op_sel_hi:[1,0,1]
  v_lshlrev_b32 v102, 16, v111
  v_and_b32 v103, s67, v111
  v_pk_fma_f32 v[54:55], v[102:103], v[32:33], v[54:55] op_sel_hi:[1,0,1]
  v_lshlrev_b32 v96, 16, v112
  v_and_b32 v97, s67, v112
  v_pk_fma_f32 v[56:57], v[96:97], v[32:33], v[56:57] op_sel_hi:[1,0,1]
  v_lshlrev_b32 v98, 16, v113
  v_and_b32 v99, s67, v113
  v_pk_fma_f32 v[58:59], v[98:99], v[32:33], v[58:59] op_sel_hi:[1,0,1]
  v_lshlrev_b32 v100, 16, v114
  v_and_b32 v101, s67, v114
  v_pk_fma_f32 v[60:61], v[100:101], v[32:33], v[60:61] op_sel_hi:[1,0,1]
  v_lshlrev_b32 v102, 16, v115
  v_and_b32 v103, s67, v115
  v_pk_fma_f32 v[62:63], v[102:103], v[32:33], v[62:63] op_sel_hi:[1,0,1]
  v_lshlrev_b32 v96, 16, v116
  v_and_b32 v97, s67, v116
  v_pk_fma_f32 v[64:65], v[96:97], v[32:33], v[64:65] op_sel_hi:[1,0,1]
  v_lshlrev_b32 v98, 16, v117
  v_and_b32 v99, s67, v117
  v_pk_fma_f32 v[66:67], v[98:99], v[32:33], v[66:67] op_sel_hi:[1,0,1]
  v_lshlrev_b32 v100, 16, v118
  v_and_b32 v101, s67, v118
  v_pk_fma_f32 v[68:69], v[100:101], v[32:33], v[68:69] op_sel_hi:[1,0,1]
  v_lshlrev_b32 v102, 16, v119
  v_and_b32 v103, s67, v119
  v_pk_fma_f32 v[70:71], v[102:103], v[32:33], v[70:71] op_sel_hi:[1,0,1]
  s_mov_b32 s64, 344064
  buffer_load_dwordx4 v[108:111], v1, s[28:31], s64 offen offset:0 nt
  buffer_load_dwordx4 v[112:115], v1, s[28:31], s64 offen offset:128 nt
  buffer_load_dwordx4 v[116:119], v1, s[28:31], s64 offen offset:256 nt
  s_waitcnt vmcnt(33)
  v_lshlrev_b32 v96, 16, v120
  v_and_b32 v97, s67, v120
  v_pk_fma_f32 v[48:49], v[96:97], v[32:33], v[48:49] op_sel:[0,1,0] op_sel_hi:[1,1,1]
  v_lshlrev_b32 v98, 16, v121
  v_and_b32 v99, s67, v121
  v_pk_fma_f32 v[50:51], v[98:99], v[32:33], v[50:51] op_sel:[0,1,0] op_sel_hi:[1,1,1]
  v_lshlrev_b32 v100, 16, v122
  v_and_b32 v101, s67, v122
  v_pk_fma_f32 v[52:53], v[100:101], v[32:33], v[52:53] op_sel:[0,1,0] op_sel_hi:[1,1,1]
  v_lshlrev_b32 v102, 16, v123
  v_and_b32 v103, s67, v123
  v_pk_fma_f32 v[54:55], v[102:103], v[32:33], v[54:55] op_sel:[0,1,0] op_sel_hi:[1,1,1]
  v_lshlrev_b32 v96, 16, v124
  v_and_b32 v97, s67, v124
  v_pk_fma_f32 v[56:57], v[96:97], v[32:33], v[56:57] op_sel:[0,1,0] op_sel_hi:[1,1,1]
  v_lshlrev_b32 v98, 16, v125
  v_and_b32 v99, s67, v125
  v_pk_fma_f32 v[58:59], v[98:99], v[32:33], v[58:59] op_sel:[0,1,0] op_sel_hi:[1,1,1]
  v_lshlrev_b32 v100, 16, v126
  v_and_b32 v101, s67, v126
  v_pk_fma_f32 v[60:61], v[100:101], v[32:33], v[60:61] op_sel:[0,1,0] op_sel_hi:[1,1,1]
  v_lshlrev_b32 v102, 16, v127
  v_and_b32 v103, s67, v127
  v_pk_fma_f32 v[62:63], v[102:103], v[32:33], v[62:63] op_sel:[0,1,0] op_sel_hi:[1,1,1]
  v_lshlrev_b32 v96, 16, v128
  v_and_b32 v97, s67, v128
  v_pk_fma_f32 v[64:65], v[96:97], v[32:33], v[64:65] op_sel:[0,1,0] op_sel_hi:[1,1,1]
  v_lshlrev_b32 v98, 16, v129
  v_and_b32 v99, s67, v129
  v_pk_fma_f32 v[66:67], v[98:99], v[32:33], v[66:67] op_sel:[0,1,0] op_sel_hi:[1,1,1]
  v_lshlrev_b32 v100, 16, v130
  v_and_b32 v101, s67, v130
  v_pk_fma_f32 v[68:69], v[100:101], v[32:33], v[68:69] op_sel:[0,1,0] op_sel_hi:[1,1,1]
  v_lshlrev_b32 v102, 16, v131
  v_and_b32 v103, s67, v131
  v_pk_fma_f32 v[70:71], v[102:103], v[32:33], v[70:71] op_sel:[0,1,0] op_sel_hi:[1,1,1]
  s_mov_b32 s64, 356352
  buffer_load_dwordx4 v[120:123], v1, s[28:31], s64 offen offset:0 nt
  buffer_load_dwordx4 v[124:127], v1, s[28:31], s64 offen offset:128 nt
  buffer_load_dwordx4 v[128:131], v1, s[28:31], s64 offen offset:256 nt
  s_waitcnt vmcnt(33)
  v_lshlrev_b32 v96, 16, v132
  v_and_b32 v97, s67, v132
  v_pk_fma_f32 v[48:49], v[96:97], v[34:35], v[48:49] op_sel_hi:[1,0,1]
  v_lshlrev_b32 v98, 16, v133
  v_and_b32 v99, s67, v133
  v_pk_fma_f32 v[50:51], v[98:99], v[34:35], v[50:51] op_sel_hi:[1,0,1]
  v_lshlrev_b32 v100, 16, v134
  v_and_b32 v101, s67, v134
  v_pk_fma_f32 v[52:53], v[100:101], v[34:35], v[52:53] op_sel_hi:[1,0,1]
  v_lshlrev_b32 v102, 16, v135
  v_and_b32 v103, s67, v135
  v_pk_fma_f32 v[54:55], v[102:103], v[34:35], v[54:55] op_sel_hi:[1,0,1]
  v_lshlrev_b32 v96, 16, v136
  v_and_b32 v97, s67, v136
  v_pk_fma_f32 v[56:57], v[96:97], v[34:35], v[56:57] op_sel_hi:[1,0,1]
  v_lshlrev_b32 v98, 16, v137
  v_and_b32 v99, s67, v137
  v_pk_fma_f32 v[58:59], v[98:99], v[34:35], v[58:59] op_sel_hi:[1,0,1]
  v_lshlrev_b32 v100, 16, v138
  v_and_b32 v101, s67, v138
  v_pk_fma_f32 v[60:61], v[100:101], v[34:35], v[60:61] op_sel_hi:[1,0,1]
  v_lshlrev_b32 v102, 16, v139
  v_and_b32 v103, s67, v139
  v_pk_fma_f32 v[62:63], v[102:103], v[34:35], v[62:63] op_sel_hi:[1,0,1]
  v_lshlrev_b32 v96, 16, v140
  v_and_b32 v97, s67, v140
  v_pk_fma_f32 v[64:65], v[96:97], v[34:35], v[64:65] op_sel_hi:[1,0,1]
  v_lshlrev_b32 v98, 16, v141
  v_and_b32 v99, s67, v141
  v_pk_fma_f32 v[66:67], v[98:99], v[34:35], v[66:67] op_sel_hi:[1,0,1]
  v_lshlrev_b32 v100, 16, v142
  v_and_b32 v101, s67, v142
  v_pk_fma_f32 v[68:69], v[100:101], v[34:35], v[68:69] op_sel_hi:[1,0,1]
  v_lshlrev_b32 v102, 16, v143
  v_and_b32 v103, s67, v143
  v_pk_fma_f32 v[70:71], v[102:103], v[34:35], v[70:71] op_sel_hi:[1,0,1]
  s_mov_b32 s64, 368640
  buffer_load_dwordx4 v[132:135], v1, s[28:31], s64 offen offset:0 nt
  buffer_load_dwordx4 v[136:139], v1, s[28:31], s64 offen offset:128 nt
  buffer_load_dwordx4 v[140:143], v1, s[28:31], s64 offen offset:256 nt
  s_waitcnt vmcnt(33)
  v_lshlrev_b32 v96, 16, v144
  v_and_b32 v97, s67, v144
  v_pk_fma_f32 v[48:49], v[96:97], v[34:35], v[48:49] op_sel:[0,1,0] op_sel_hi:[1,1,1]
  v_lshlrev_b32 v98, 16, v145
  v_and_b32 v99, s67, v145
  v_pk_fma_f32 v[50:51], v[98:99], v[34:35], v[50:51] op_sel:[0,1,0] op_sel_hi:[1,1,1]
  v_lshlrev_b32 v100, 16, v146
  v_and_b32 v101, s67, v146
  v_pk_fma_f32 v[52:53], v[100:101], v[34:35], v[52:53] op_sel:[0,1,0] op_sel_hi:[1,1,1]
  v_lshlrev_b32 v102, 16, v147
  v_and_b32 v103, s67, v147
  v_pk_fma_f32 v[54:55], v[102:103], v[34:35], v[54:55] op_sel:[0,1,0] op_sel_hi:[1,1,1]
  v_lshlrev_b32 v96, 16, v148
  v_and_b32 v97, s67, v148
  v_pk_fma_f32 v[56:57], v[96:97], v[34:35], v[56:57] op_sel:[0,1,0] op_sel_hi:[1,1,1]
  v_lshlrev_b32 v98, 16, v149
  v_and_b32 v99, s67, v149
  v_pk_fma_f32 v[58:59], v[98:99], v[34:35], v[58:59] op_sel:[0,1,0] op_sel_hi:[1,1,1]
  v_lshlrev_b32 v100, 16, v150
  v_and_b32 v101, s67, v150
  v_pk_fma_f32 v[60:61], v[100:101], v[34:35], v[60:61] op_sel:[0,1,0] op_sel_hi:[1,1,1]
  v_lshlrev_b32 v102, 16, v151
  v_and_b32 v103, s67, v151
  v_pk_fma_f32 v[62:63], v[102:103], v[34:35], v[62:63] op_sel:[0,1,0] op_sel_hi:[1,1,1]
  v_lshlrev_b32 v96, 16, v152
  v_and_b32 v97, s67, v152
  v_pk_fma_f32 v[64:65], v[96:97], v[34:35], v[64:65] op_sel:[0,1,0] op_sel_hi:[1,1,1]
  v_lshlrev_b32 v98, 16, v153
  v_and_b32 v99, s67, v153
  v_pk_fma_f32 v[66:67], v[98:99], v[34:35], v[66:67] op_sel:[0,1,0] op_sel_hi:[1,1,1]
  v_lshlrev_b32 v100, 16, v154
  v_and_b32 v101, s67, v154
  v_pk_fma_f32 v[68:69], v[100:101], v[34:35], v[68:69] op_sel:[0,1,0] op_sel_hi:[1,1,1]
  v_lshlrev_b32 v102, 16, v155
  v_and_b32 v103, s67, v155
  v_pk_fma_f32 v[70:71], v[102:103], v[34:35], v[70:71] op_sel:[0,1,0] op_sel_hi:[1,1,1]
  s_mov_b32 s64, 380928
  buffer_load_dwordx4 v[144:147], v1, s[28:31], s64 offen offset:0 nt
  buffer_load_dwordx4 v[148:151], v1, s[28:31], s64 offen offset:128 nt
  buffer_load_dwordx4 v[152:155], v1, s[28:31], s64 offen offset:256 nt
  s_waitcnt vmcnt(33)
  v_lshlrev_b32 v96, 16, v156
  v_and_b32 v97, s67, v156
  v_pk_fma_f32 v[48:49], v[96:97], v[36:37], v[48:49] op_sel_hi:[1,0,1]
  v_lshlrev_b32 v98, 16, v157
  v_and_b32 v99, s67, v157
  v_pk_fma_f32 v[50:51], v[98:99], v[36:37], v[50:51] op_sel_hi:[1,0,1]
  v_lshlrev_b32 v100, 16, v158
  v_and_b32 v101, s67, v158
  v_pk_fma_f32 v[52:53], v[100:101], v[36:37], v[52:53] op_sel_hi:[1,0,1]
  v_lshlrev_b32 v102, 16, v159
  v_and_b32 v103, s67, v159
  v_pk_fma_f32 v[54:55], v[102:103], v[36:37], v[54:55] op_sel_hi:[1,0,1]
  v_lshlrev_b32 v96, 16, v160
  v_and_b32 v97, s67, v160
  v_pk_fma_f32 v[56:57], v[96:97], v[36:37], v[56:57] op_sel_hi:[1,0,1]
  v_lshlrev_b32 v98, 16, v161
  v_and_b32 v99, s67, v161
  v_pk_fma_f32 v[58:59], v[98:99], v[36:37], v[58:59] op_sel_hi:[1,0,1]
  v_lshlrev_b32 v100, 16, v162
  v_and_b32 v101, s67, v162
  v_pk_fma_f32 v[60:61], v[100:101], v[36:37], v[60:61] op_sel_hi:[1,0,1]
  v_lshlrev_b32 v102, 16, v163
  v_and_b32 v103, s67, v163
  v_pk_fma_f32 v[62:63], v[102:103], v[36:37], v[62:63] op_sel_hi:[1,0,1]
  v_lshlrev_b32 v96, 16, v164
  v_and_b32 v97, s67, v164
  v_pk_fma_f32 v[64:65], v[96:97], v[36:37], v[64:65] op_sel_hi:[1,0,1]
  v_lshlrev_b32 v98, 16, v165
  v_and_b32 v99, s67, v165
  v_pk_fma_f32 v[66:67], v[98:99], v[36:37], v[66:67] op_sel_hi:[1,0,1]
  v_lshlrev_b32 v100, 16, v166
  v_and_b32 v101, s67, v166
  v_pk_fma_f32 v[68:69], v[100:101], v[36:37], v[68:69] op_sel_hi:[1,0,1]
  v_lshlrev_b32 v102, 16, v167
  v_and_b32 v103, s67, v167
  v_pk_fma_f32 v[70:71], v[102:103], v[36:37], v[70:71] op_sel_hi:[1,0,1]
  s_waitcnt vmcnt(30)
  v_lshlrev_b32 v96, 16, v168
  v_and_b32 v97, s67, v168
  v_pk_fma_f32 v[48:49], v[96:97], v[36:37], v[48:49] op_sel:[0,1,0] op_sel_hi:[1,1,1]
  v_lshlrev_b32 v98, 16, v169
  v_and_b32 v99, s67, v169
  v_pk_fma_f32 v[50:51], v[98:99], v[36:37], v[50:51] op_sel:[0,1,0] op_sel_hi:[1,1,1]
  v_lshlrev_b32 v100, 16, v170
  v_and_b32 v101, s67, v170
  v_pk_fma_f32 v[52:53], v[100:101], v[36:37], v[52:53] op_sel:[0,1,0] op_sel_hi:[1,1,1]
  v_lshlrev_b32 v102, 16, v171
  v_and_b32 v103, s67, v171
  v_pk_fma_f32 v[54:55], v[102:103], v[36:37], v[54:55] op_sel:[0,1,0] op_sel_hi:[1,1,1]
  v_lshlrev_b32 v96, 16, v172
  v_and_b32 v97, s67, v172
  v_pk_fma_f32 v[56:57], v[96:97], v[36:37], v[56:57] op_sel:[0,1,0] op_sel_hi:[1,1,1]
  v_lshlrev_b32 v98, 16, v173
  v_and_b32 v99, s67, v173
  v_pk_fma_f32 v[58:59], v[98:99], v[36:37], v[58:59] op_sel:[0,1,0] op_sel_hi:[1,1,1]
  v_lshlrev_b32 v100, 16, v174
  v_and_b32 v101, s67, v174
  v_pk_fma_f32 v[60:61], v[100:101], v[36:37], v[60:61] op_sel:[0,1,0] op_sel_hi:[1,1,1]
  v_lshlrev_b32 v102, 16, v175
  v_and_b32 v103, s67, v175
  v_pk_fma_f32 v[62:63], v[102:103], v[36:37], v[62:63] op_sel:[0,1,0] op_sel_hi:[1,1,1]
  v_lshlrev_b32 v96, 16, v176
  v_and_b32 v97, s67, v176
  v_pk_fma_f32 v[64:65], v[96:97], v[36:37], v[64:65] op_sel:[0,1,0] op_sel_hi:[1,1,1]
  v_lshlrev_b32 v98, 16, v177
  v_and_b32 v99, s67, v177
  v_pk_fma_f32 v[66:67], v[98:99], v[36:37], v[66:67] op_sel:[0,1,0] op_sel_hi:[1,1,1]
  v_lshlrev_b32 v100, 16, v178
  v_and_b32 v101, s67, v178
  v_pk_fma_f32 v[68:69], v[100:101], v[36:37], v[68:69] op_sel:[0,1,0] op_sel_hi:[1,1,1]
  v_lshlrev_b32 v102, 16, v179
  v_and_b32 v103, s67, v179
  v_pk_fma_f32 v[70:71], v[102:103], v[36:37], v[70:71] op_sel:[0,1,0] op_sel_hi:[1,1,1]
  s_waitcnt vmcnt(27)
  v_lshlrev_b32 v96, 16, v180
  v_and_b32 v97, s67, v180
  v_pk_fma_f32 v[48:49], v[96:97], v[38:39], v[48:49] op_sel_hi:[1,0,1]
  v_lshlrev_b32 v98, 16, v181
  v_and_b32 v99, s67, v181
  v_pk_fma_f32 v[50:51], v[98:99], v[38:39], v[50:51] op_sel_hi:[1,0,1]
  v_lshlrev_b32 v100, 16, v182
  v_and_b32 v101, s67, v182
  v_pk_fma_f32 v[52:53], v[100:101], v[38:39], v[52:53] op_sel_hi:[1,0,1]
  v_lshlrev_b32 v102, 16, v183
  v_and_b32 v103, s67, v183
  v_pk_fma_f32 v[54:55], v[102:103], v[38:39], v[54:55] op_sel_hi:[1,0,1]
  v_lshlrev_b32 v96, 16, v184
  v_and_b32 v97, s67, v184
  v_pk_fma_f32 v[56:57], v[96:97], v[38:39], v[56:57] op_sel_hi:[1,0,1]
  v_lshlrev_b32 v98, 16, v185
  v_and_b32 v99, s67, v185
  v_pk_fma_f32 v[58:59], v[98:99], v[38:39], v[58:59] op_sel_hi:[1,0,1]
  v_lshlrev_b32 v100, 16, v186
  v_and_b32 v101, s67, v186
  v_pk_fma_f32 v[60:61], v[100:101], v[38:39], v[60:61] op_sel_hi:[1,0,1]
  v_lshlrev_b32 v102, 16, v187
  v_and_b32 v103, s67, v187
  v_pk_fma_f32 v[62:63], v[102:103], v[38:39], v[62:63] op_sel_hi:[1,0,1]
  v_lshlrev_b32 v96, 16, v188
  v_and_b32 v97, s67, v188
  v_pk_fma_f32 v[64:65], v[96:97], v[38:39], v[64:65] op_sel_hi:[1,0,1]
  v_lshlrev_b32 v98, 16, v189
  v_and_b32 v99, s67, v189
  v_pk_fma_f32 v[66:67], v[98:99], v[38:39], v[66:67] op_sel_hi:[1,0,1]
  v_lshlrev_b32 v100, 16, v190
  v_and_b32 v101, s67, v190
  v_pk_fma_f32 v[68:69], v[100:101], v[38:39], v[68:69] op_sel_hi:[1,0,1]
  v_lshlrev_b32 v102, 16, v191
  v_and_b32 v103, s67, v191
  v_pk_fma_f32 v[70:71], v[102:103], v[38:39], v[70:71] op_sel_hi:[1,0,1]
  s_waitcnt vmcnt(24)
  v_lshlrev_b32 v96, 16, v192
  v_and_b32 v97, s67, v192
  v_pk_fma_f32 v[48:49], v[96:97], v[38:39], v[48:49] op_sel:[0,1,0] op_sel_hi:[1,1,1]
  v_lshlrev_b32 v98, 16, v193
  v_and_b32 v99, s67, v193
  v_pk_fma_f32 v[50:51], v[98:99], v[38:39], v[50:51] op_sel:[0,1,0] op_sel_hi:[1,1,1]
  v_lshlrev_b32 v100, 16, v194
  v_and_b32 v101, s67, v194
  v_pk_fma_f32 v[52:53], v[100:101], v[38:39], v[52:53] op_sel:[0,1,0] op_sel_hi:[1,1,1]
  v_lshlrev_b32 v102, 16, v195
  v_and_b32 v103, s67, v195
  v_pk_fma_f32 v[54:55], v[102:103], v[38:39], v[54:55] op_sel:[0,1,0] op_sel_hi:[1,1,1]
  v_lshlrev_b32 v96, 16, v196
  v_and_b32 v97, s67, v196
  v_pk_fma_f32 v[56:57], v[96:97], v[38:39], v[56:57] op_sel:[0,1,0] op_sel_hi:[1,1,1]
  v_lshlrev_b32 v98, 16, v197
  v_and_b32 v99, s67, v197
  v_pk_fma_f32 v[58:59], v[98:99], v[38:39], v[58:59] op_sel:[0,1,0] op_sel_hi:[1,1,1]
  v_lshlrev_b32 v100, 16, v198
  v_and_b32 v101, s67, v198
  v_pk_fma_f32 v[60:61], v[100:101], v[38:39], v[60:61] op_sel:[0,1,0] op_sel_hi:[1,1,1]
  v_lshlrev_b32 v102, 16, v199
  v_and_b32 v103, s67, v199
  v_pk_fma_f32 v[62:63], v[102:103], v[38:39], v[62:63] op_sel:[0,1,0] op_sel_hi:[1,1,1]
  v_lshlrev_b32 v96, 16, v200
  v_and_b32 v97, s67, v200
  v_pk_fma_f32 v[64:65], v[96:97], v[38:39], v[64:65] op_sel:[0,1,0] op_sel_hi:[1,1,1]
  v_lshlrev_b32 v98, 16, v201
  v_and_b32 v99, s67, v201
  v_pk_fma_f32 v[66:67], v[98:99], v[38:39], v[66:67] op_sel:[0,1,0] op_sel_hi:[1,1,1]
  v_lshlrev_b32 v100, 16, v202
  v_and_b32 v101, s67, v202
  v_pk_fma_f32 v[68:69], v[100:101], v[38:39], v[68:69] op_sel:[0,1,0] op_sel_hi:[1,1,1]
  v_lshlrev_b32 v102, 16, v203
  v_and_b32 v103, s67, v203
  v_pk_fma_f32 v[70:71], v[102:103], v[38:39], v[70:71] op_sel:[0,1,0] op_sel_hi:[1,1,1]
  s_waitcnt vmcnt(21)
  v_lshlrev_b32 v96, 16, v204
  v_and_b32 v97, s67, v204
  v_pk_fma_f32 v[48:49], v[96:97], v[40:41], v[48:49] op_sel_hi:[1,0,1]
  v_lshlrev_b32 v98, 16, v205
  v_and_b32 v99, s67, v205
  v_pk_fma_f32 v[50:51], v[98:99], v[40:41], v[50:51] op_sel_hi:[1,0,1]
  v_lshlrev_b32 v100, 16, v206
  v_and_b32 v101, s67, v206
  v_pk_fma_f32 v[52:53], v[100:101], v[40:41], v[52:53] op_sel_hi:[1,0,1]
  v_lshlrev_b32 v102, 16, v207
  v_and_b32 v103, s67, v207
  v_pk_fma_f32 v[54:55], v[102:103], v[40:41], v[54:55] op_sel_hi:[1,0,1]
  v_lshlrev_b32 v96, 16, v208
  v_and_b32 v97, s67, v208
  v_pk_fma_f32 v[56:57], v[96:97], v[40:41], v[56:57] op_sel_hi:[1,0,1]
  v_lshlrev_b32 v98, 16, v209
  v_and_b32 v99, s67, v209
  v_pk_fma_f32 v[58:59], v[98:99], v[40:41], v[58:59] op_sel_hi:[1,0,1]
  v_lshlrev_b32 v100, 16, v210
  v_and_b32 v101, s67, v210
  v_pk_fma_f32 v[60:61], v[100:101], v[40:41], v[60:61] op_sel_hi:[1,0,1]
  v_lshlrev_b32 v102, 16, v211
  v_and_b32 v103, s67, v211
  v_pk_fma_f32 v[62:63], v[102:103], v[40:41], v[62:63] op_sel_hi:[1,0,1]
  v_lshlrev_b32 v96, 16, v212
  v_and_b32 v97, s67, v212
  v_pk_fma_f32 v[64:65], v[96:97], v[40:41], v[64:65] op_sel_hi:[1,0,1]
  v_lshlrev_b32 v98, 16, v213
  v_and_b32 v99, s67, v213
  v_pk_fma_f32 v[66:67], v[98:99], v[40:41], v[66:67] op_sel_hi:[1,0,1]
  v_lshlrev_b32 v100, 16, v214
  v_and_b32 v101, s67, v214
  v_pk_fma_f32 v[68:69], v[100:101], v[40:41], v[68:69] op_sel_hi:[1,0,1]
  v_lshlrev_b32 v102, 16, v215
  v_and_b32 v103, s67, v215
  v_pk_fma_f32 v[70:71], v[102:103], v[40:41], v[70:71] op_sel_hi:[1,0,1]
  s_waitcnt vmcnt(18)
  v_lshlrev_b32 v96, 16, v216
  v_and_b32 v97, s67, v216
  v_pk_fma_f32 v[48:49], v[96:97], v[40:41], v[48:49] op_sel:[0,1,0] op_sel_hi:[1,1,1]
  v_lshlrev_b32 v98, 16, v217
  v_and_b32 v99, s67, v217
  v_pk_fma_f32 v[50:51], v[98:99], v[40:41], v[50:51] op_sel:[0,1,0] op_sel_hi:[1,1,1]
  v_lshlrev_b32 v100, 16, v218
  v_and_b32 v101, s67, v218
  v_pk_fma_f32 v[52:53], v[100:101], v[40:41], v[52:53] op_sel:[0,1,0] op_sel_hi:[1,1,1]
  v_lshlrev_b32 v102, 16, v219
  v_and_b32 v103, s67, v219
  v_pk_fma_f32 v[54:55], v[102:103], v[40:41], v[54:55] op_sel:[0,1,0] op_sel_hi:[1,1,1]
  v_lshlrev_b32 v96, 16, v220
  v_and_b32 v97, s67, v220
  v_pk_fma_f32 v[56:57], v[96:97], v[40:41], v[56:57] op_sel:[0,1,0] op_sel_hi:[1,1,1]
  v_lshlrev_b32 v98, 16, v221
  v_and_b32 v99, s67, v221
  v_pk_fma_f32 v[58:59], v[98:99], v[40:41], v[58:59] op_sel:[0,1,0] op_sel_hi:[1,1,1]
  v_lshlrev_b32 v100, 16, v222
  v_and_b32 v101, s67, v222
  v_pk_fma_f32 v[60:61], v[100:101], v[40:41], v[60:61] op_sel:[0,1,0] op_sel_hi:[1,1,1]
  v_lshlrev_b32 v102, 16, v223
  v_and_b32 v103, s67, v223
  v_pk_fma_f32 v[62:63], v[102:103], v[40:41], v[62:63] op_sel:[0,1,0] op_sel_hi:[1,1,1]
  v_lshlrev_b32 v96, 16, v224
  v_and_b32 v97, s67, v224
  v_pk_fma_f32 v[64:65], v[96:97], v[40:41], v[64:65] op_sel:[0,1,0] op_sel_hi:[1,1,1]
  v_lshlrev_b32 v98, 16, v225
  v_and_b32 v99, s67, v225
  v_pk_fma_f32 v[66:67], v[98:99], v[40:41], v[66:67] op_sel:[0,1,0] op_sel_hi:[1,1,1]
  v_lshlrev_b32 v100, 16, v226
  v_and_b32 v101, s67, v226
  v_pk_fma_f32 v[68:69], v[100:101], v[40:41], v[68:69] op_sel:[0,1,0] op_sel_hi:[1,1,1]
  v_lshlrev_b32 v102, 16, v227
  v_and_b32 v103, s67, v227
  v_pk_fma_f32 v[70:71], v[102:103], v[40:41], v[70:71] op_sel:[0,1,0] op_sel_hi:[1,1,1]
  s_waitcnt vmcnt(15)
  v_lshlrev_b32 v96, 16, v228
  v_and_b32 v97, s67, v228
  v_pk_fma_f32 v[48:49], v[96:97], v[42:43], v[48:49] op_sel_hi:[1,0,1]
  v_lshlrev_b32 v98, 16, v229
  v_and_b32 v99, s67, v229
  v_pk_fma_f32 v[50:51], v[98:99], v[42:43], v[50:51] op_sel_hi:[1,0,1]
  v_lshlrev_b32 v100, 16, v230
  v_and_b32 v101, s67, v230
  v_pk_fma_f32 v[52:53], v[100:101], v[42:43], v[52:53] op_sel_hi:[1,0,1]
  v_lshlrev_b32 v102, 16, v231
  v_and_b32 v103, s67, v231
  v_pk_fma_f32 v[54:55], v[102:103], v[42:43], v[54:55] op_sel_hi:[1,0,1]
  v_lshlrev_b32 v96, 16, v232
  v_and_b32 v97, s67, v232
  v_pk_fma_f32 v[56:57], v[96:97], v[42:43], v[56:57] op_sel_hi:[1,0,1]
  v_lshlrev_b32 v98, 16, v233
  v_and_b32 v99, s67, v233
  v_pk_fma_f32 v[58:59], v[98:99], v[42:43], v[58:59] op_sel_hi:[1,0,1]
  v_lshlrev_b32 v100, 16, v234
  v_and_b32 v101, s67, v234
  v_pk_fma_f32 v[60:61], v[100:101], v[42:43], v[60:61] op_sel_hi:[1,0,1]
  v_lshlrev_b32 v102, 16, v235
  v_and_b32 v103, s67, v235
  v_pk_fma_f32 v[62:63], v[102:103], v[42:43], v[62:63] op_sel_hi:[1,0,1]
  v_lshlrev_b32 v96, 16, v236
  v_and_b32 v97, s67, v236
  v_pk_fma_f32 v[64:65], v[96:97], v[42:43], v[64:65] op_sel_hi:[1,0,1]
  v_lshlrev_b32 v98, 16, v237
  v_and_b32 v99, s67, v237
  v_pk_fma_f32 v[66:67], v[98:99], v[42:43], v[66:67] op_sel_hi:[1,0,1]
  v_lshlrev_b32 v100, 16, v238
  v_and_b32 v101, s67, v238
  v_pk_fma_f32 v[68:69], v[100:101], v[42:43], v[68:69] op_sel_hi:[1,0,1]
  v_lshlrev_b32 v102, 16, v239
  v_and_b32 v103, s67, v239
  v_pk_fma_f32 v[70:71], v[102:103], v[42:43], v[70:71] op_sel_hi:[1,0,1]
  s_waitcnt vmcnt(12)
  v_lshlrev_b32 v96, 16, v240
  v_and_b32 v97, s67, v240
  v_pk_fma_f32 v[48:49], v[96:97], v[42:43], v[48:49] op_sel:[0,1,0] op_sel_hi:[1,1,1]
  v_lshlrev_b32 v98, 16, v241
  v_and_b32 v99, s67, v241
  v_pk_fma_f32 v[50:51], v[98:99], v[42:43], v[50:51] op_sel:[0,1,0] op_sel_hi:[1,1,1]
  v_lshlrev_b32 v100, 16, v242
  v_and_b32 v101, s67, v242
  v_pk_fma_f32 v[52:53], v[100:101], v[42:43], v[52:53] op_sel:[0,1,0] op_sel_hi:[1,1,1]
  v_lshlrev_b32 v102, 16, v243
  v_and_b32 v103, s67, v243
  v_pk_fma_f32 v[54:55], v[102:103], v[42:43], v[54:55] op_sel:[0,1,0] op_sel_hi:[1,1,1]
  v_lshlrev_b32 v96, 16, v244
  v_and_b32 v97, s67, v244
  v_pk_fma_f32 v[56:57], v[96:97], v[42:43], v[56:57] op_sel:[0,1,0] op_sel_hi:[1,1,1]
  v_lshlrev_b32 v98, 16, v245
  v_and_b32 v99, s67, v245
  v_pk_fma_f32 v[58:59], v[98:99], v[42:43], v[58:59] op_sel:[0,1,0] op_sel_hi:[1,1,1]
  v_lshlrev_b32 v100, 16, v246
  v_and_b32 v101, s67, v246
  v_pk_fma_f32 v[60:61], v[100:101], v[42:43], v[60:61] op_sel:[0,1,0] op_sel_hi:[1,1,1]
  v_lshlrev_b32 v102, 16, v247
  v_and_b32 v103, s67, v247
  v_pk_fma_f32 v[62:63], v[102:103], v[42:43], v[62:63] op_sel:[0,1,0] op_sel_hi:[1,1,1]
  v_lshlrev_b32 v96, 16, v248
  v_and_b32 v97, s67, v248
  v_pk_fma_f32 v[64:65], v[96:97], v[42:43], v[64:65] op_sel:[0,1,0] op_sel_hi:[1,1,1]
  v_lshlrev_b32 v98, 16, v249
  v_and_b32 v99, s67, v249
  v_pk_fma_f32 v[66:67], v[98:99], v[42:43], v[66:67] op_sel:[0,1,0] op_sel_hi:[1,1,1]
  v_lshlrev_b32 v100, 16, v250
  v_and_b32 v101, s67, v250
  v_pk_fma_f32 v[68:69], v[100:101], v[42:43], v[68:69] op_sel:[0,1,0] op_sel_hi:[1,1,1]
  v_lshlrev_b32 v102, 16, v251
  v_and_b32 v103, s67, v251
  v_pk_fma_f32 v[70:71], v[102:103], v[42:43], v[70:71] op_sel:[0,1,0] op_sel_hi:[1,1,1]
  s_waitcnt vmcnt(9)
  v_lshlrev_b32 v96, 16, v108
  v_and_b32 v97, s67, v108
  v_pk_fma_f32 v[48:49], v[96:97], v[44:45], v[48:49] op_sel_hi:[1,0,1]
  v_lshlrev_b32 v98, 16, v109
  v_and_b32 v99, s67, v109
  v_pk_fma_f32 v[50:51], v[98:99], v[44:45], v[50:51] op_sel_hi:[1,0,1]
  v_lshlrev_b32 v100, 16, v110
  v_and_b32 v101, s67, v110
  v_pk_fma_f32 v[52:53], v[100:101], v[44:45], v[52:53] op_sel_hi:[1,0,1]
  v_lshlrev_b32 v102, 16, v111
  v_and_b32 v103, s67, v111
  v_pk_fma_f32 v[54:55], v[102:103], v[44:45], v[54:55] op_sel_hi:[1,0,1]
  v_lshlrev_b32 v96, 16, v112
  v_and_b32 v97, s67, v112
  v_pk_fma_f32 v[56:57], v[96:97], v[44:45], v[56:57] op_sel_hi:[1,0,1]
  v_lshlrev_b32 v98, 16, v113
  v_and_b32 v99, s67, v113
  v_pk_fma_f32 v[58:59], v[98:99], v[44:45], v[58:59] op_sel_hi:[1,0,1]
  v_lshlrev_b32 v100, 16, v114
  v_and_b32 v101, s67, v114
  v_pk_fma_f32 v[60:61], v[100:101], v[44:45], v[60:61] op_sel_hi:[1,0,1]
  v_lshlrev_b32 v102, 16, v115
  v_and_b32 v103, s67, v115
  v_pk_fma_f32 v[62:63], v[102:103], v[44:45], v[62:63] op_sel_hi:[1,0,1]
  v_lshlrev_b32 v96, 16, v116
  v_and_b32 v97, s67, v116
  v_pk_fma_f32 v[64:65], v[96:97], v[44:45], v[64:65] op_sel_hi:[1,0,1]
  v_lshlrev_b32 v98, 16, v117
  v_and_b32 v99, s67, v117
  v_pk_fma_f32 v[66:67], v[98:99], v[44:45], v[66:67] op_sel_hi:[1,0,1]
  v_lshlrev_b32 v100, 16, v118
  v_and_b32 v101, s67, v118
  v_pk_fma_f32 v[68:69], v[100:101], v[44:45], v[68:69] op_sel_hi:[1,0,1]
  v_lshlrev_b32 v102, 16, v119
  v_and_b32 v103, s67, v119
  v_pk_fma_f32 v[70:71], v[102:103], v[44:45], v[70:71] op_sel_hi:[1,0,1]
  s_waitcnt vmcnt(6)
  v_lshlrev_b32 v96, 16, v120
  v_and_b32 v97, s67, v120
  v_pk_fma_f32 v[48:49], v[96:97], v[44:45], v[48:49] op_sel:[0,1,0] op_sel_hi:[1,1,1]
  v_lshlrev_b32 v98, 16, v121
  v_and_b32 v99, s67, v121
  v_pk_fma_f32 v[50:51], v[98:99], v[44:45], v[50:51] op_sel:[0,1,0] op_sel_hi:[1,1,1]
  v_lshlrev_b32 v100, 16, v122
  v_and_b32 v101, s67, v122
  v_pk_fma_f32 v[52:53], v[100:101], v[44:45], v[52:53] op_sel:[0,1,0] op_sel_hi:[1,1,1]
  v_lshlrev_b32 v102, 16, v123
  v_and_b32 v103, s67, v123
  v_pk_fma_f32 v[54:55], v[102:103], v[44:45], v[54:55] op_sel:[0,1,0] op_sel_hi:[1,1,1]
  v_lshlrev_b32 v96, 16, v124
  v_and_b32 v97, s67, v124
  v_pk_fma_f32 v[56:57], v[96:97], v[44:45], v[56:57] op_sel:[0,1,0] op_sel_hi:[1,1,1]
  v_lshlrev_b32 v98, 16, v125
  v_and_b32 v99, s67, v125
  v_pk_fma_f32 v[58:59], v[98:99], v[44:45], v[58:59] op_sel:[0,1,0] op_sel_hi:[1,1,1]
  v_lshlrev_b32 v100, 16, v126
  v_and_b32 v101, s67, v126
  v_pk_fma_f32 v[60:61], v[100:101], v[44:45], v[60:61] op_sel:[0,1,0] op_sel_hi:[1,1,1]
  v_lshlrev_b32 v102, 16, v127
  v_and_b32 v103, s67, v127
  v_pk_fma_f32 v[62:63], v[102:103], v[44:45], v[62:63] op_sel:[0,1,0] op_sel_hi:[1,1,1]
  v_lshlrev_b32 v96, 16, v128
  v_and_b32 v97, s67, v128
  v_pk_fma_f32 v[64:65], v[96:97], v[44:45], v[64:65] op_sel:[0,1,0] op_sel_hi:[1,1,1]
  v_lshlrev_b32 v98, 16, v129
  v_and_b32 v99, s67, v129
  v_pk_fma_f32 v[66:67], v[98:99], v[44:45], v[66:67] op_sel:[0,1,0] op_sel_hi:[1,1,1]
  v_lshlrev_b32 v100, 16, v130
  v_and_b32 v101, s67, v130
  v_pk_fma_f32 v[68:69], v[100:101], v[44:45], v[68:69] op_sel:[0,1,0] op_sel_hi:[1,1,1]
  v_lshlrev_b32 v102, 16, v131
  v_and_b32 v103, s67, v131
  v_pk_fma_f32 v[70:71], v[102:103], v[44:45], v[70:71] op_sel:[0,1,0] op_sel_hi:[1,1,1]
  s_waitcnt vmcnt(3)
  v_lshlrev_b32 v96, 16, v132
  v_and_b32 v97, s67, v132
  v_pk_fma_f32 v[48:49], v[96:97], v[46:47], v[48:49] op_sel_hi:[1,0,1]
  v_lshlrev_b32 v98, 16, v133
  v_and_b32 v99, s67, v133
  v_pk_fma_f32 v[50:51], v[98:99], v[46:47], v[50:51] op_sel_hi:[1,0,1]
  v_lshlrev_b32 v100, 16, v134
  v_and_b32 v101, s67, v134
  v_pk_fma_f32 v[52:53], v[100:101], v[46:47], v[52:53] op_sel_hi:[1,0,1]
  v_lshlrev_b32 v102, 16, v135
  v_and_b32 v103, s67, v135
  v_pk_fma_f32 v[54:55], v[102:103], v[46:47], v[54:55] op_sel_hi:[1,0,1]
  v_lshlrev_b32 v96, 16, v136
  v_and_b32 v97, s67, v136
  v_pk_fma_f32 v[56:57], v[96:97], v[46:47], v[56:57] op_sel_hi:[1,0,1]
  v_lshlrev_b32 v98, 16, v137
  v_and_b32 v99, s67, v137
  v_pk_fma_f32 v[58:59], v[98:99], v[46:47], v[58:59] op_sel_hi:[1,0,1]
  v_lshlrev_b32 v100, 16, v138
  v_and_b32 v101, s67, v138
  v_pk_fma_f32 v[60:61], v[100:101], v[46:47], v[60:61] op_sel_hi:[1,0,1]
  v_lshlrev_b32 v102, 16, v139
  v_and_b32 v103, s67, v139
  v_pk_fma_f32 v[62:63], v[102:103], v[46:47], v[62:63] op_sel_hi:[1,0,1]
  v_lshlrev_b32 v96, 16, v140
  v_and_b32 v97, s67, v140
  v_pk_fma_f32 v[64:65], v[96:97], v[46:47], v[64:65] op_sel_hi:[1,0,1]
  v_lshlrev_b32 v98, 16, v141
  v_and_b32 v99, s67, v141
  v_pk_fma_f32 v[66:67], v[98:99], v[46:47], v[66:67] op_sel_hi:[1,0,1]
  v_lshlrev_b32 v100, 16, v142
  v_and_b32 v101, s67, v142
  v_pk_fma_f32 v[68:69], v[100:101], v[46:47], v[68:69] op_sel_hi:[1,0,1]
  v_lshlrev_b32 v102, 16, v143
  v_and_b32 v103, s67, v143
  v_pk_fma_f32 v[70:71], v[102:103], v[46:47], v[70:71] op_sel_hi:[1,0,1]
  s_waitcnt vmcnt(0)
  v_lshlrev_b32 v96, 16, v144
  v_and_b32 v97, s67, v144
  v_pk_fma_f32 v[48:49], v[96:97], v[46:47], v[48:49] op_sel:[0,1,0] op_sel_hi:[1,1,1]
  v_lshlrev_b32 v98, 16, v145
  v_and_b32 v99, s67, v145
  v_pk_fma_f32 v[50:51], v[98:99], v[46:47], v[50:51] op_sel:[0,1,0] op_sel_hi:[1,1,1]
  v_lshlrev_b32 v100, 16, v146
  v_and_b32 v101, s67, v146
  v_pk_fma_f32 v[52:53], v[100:101], v[46:47], v[52:53] op_sel:[0,1,0] op_sel_hi:[1,1,1]
  v_lshlrev_b32 v102, 16, v147
  v_and_b32 v103, s67, v147
  v_pk_fma_f32 v[54:55], v[102:103], v[46:47], v[54:55] op_sel:[0,1,0] op_sel_hi:[1,1,1]
  v_lshlrev_b32 v96, 16, v148
  v_and_b32 v97, s67, v148
  v_pk_fma_f32 v[56:57], v[96:97], v[46:47], v[56:57] op_sel:[0,1,0] op_sel_hi:[1,1,1]
  v_lshlrev_b32 v98, 16, v149
  v_and_b32 v99, s67, v149
  v_pk_fma_f32 v[58:59], v[98:99], v[46:47], v[58:59] op_sel:[0,1,0] op_sel_hi:[1,1,1]
  v_lshlrev_b32 v100, 16, v150
  v_and_b32 v101, s67, v150
  v_pk_fma_f32 v[60:61], v[100:101], v[46:47], v[60:61] op_sel:[0,1,0] op_sel_hi:[1,1,1]
  v_lshlrev_b32 v102, 16, v151
  v_and_b32 v103, s67, v151
  v_pk_fma_f32 v[62:63], v[102:103], v[46:47], v[62:63] op_sel:[0,1,0] op_sel_hi:[1,1,1]
  v_lshlrev_b32 v96, 16, v152
  v_and_b32 v97, s67, v152
  v_pk_fma_f32 v[64:65], v[96:97], v[46:47], v[64:65] op_sel:[0,1,0] op_sel_hi:[1,1,1]
  v_lshlrev_b32 v98, 16, v153
  v_and_b32 v99, s67, v153
  v_pk_fma_f32 v[66:67], v[98:99], v[46:47], v[66:67] op_sel:[0,1,0] op_sel_hi:[1,1,1]
  v_lshlrev_b32 v100, 16, v154
  v_and_b32 v101, s67, v154
  v_pk_fma_f32 v[68:69], v[100:101], v[46:47], v[68:69] op_sel:[0,1,0] op_sel_hi:[1,1,1]
  v_lshlrev_b32 v102, 16, v155
  v_and_b32 v103, s67, v155
  v_pk_fma_f32 v[70:71], v[102:103], v[46:47], v[70:71] op_sel:[0,1,0] op_sel_hi:[1,1,1]
  s_nop 1
  v_permlane32_swap_b32 v48, v60
  v_permlane32_swap_b32 v49, v61
  v_permlane32_swap_b32 v50, v62
  v_permlane32_swap_b32 v51, v63
  v_permlane32_swap_b32 v52, v64
  v_permlane32_swap_b32 v53, v65
  v_permlane32_swap_b32 v54, v66
  v_permlane32_swap_b32 v55, v67
  v_permlane32_swap_b32 v56, v68
  v_permlane32_swap_b32 v57, v69
  v_permlane32_swap_b32 v58, v70
  v_permlane32_swap_b32 v59, v71
  s_nop 1
  v_add_f32 v48, v48, v60
  v_add_f32 v49, v49, v61
  v_add_f32 v50, v50, v62
  v_add_f32 v51, v51, v63
  v_add_f32 v52, v52, v64
  v_add_f32 v53, v53, v65
  v_add_f32 v54, v54, v66
  v_add_f32 v55, v55, v67
  v_add_f32 v56, v56, v68
  v_add_f32 v57, v57, v69
  v_add_f32 v58, v58, v70
  v_add_f32 v59, v59, v71
  s_nop 1
  v_permlane16_swap_b32 v48, v54
  v_permlane16_swap_b32 v49, v55
  v_permlane16_swap_b32 v50, v56
  v_permlane16_swap_b32 v51, v57
  v_permlane16_swap_b32 v52, v58
  v_permlane16_swap_b32 v53, v59
  s_nop 1
  v_add_f32 v48, v48, v54
  v_add_f32 v49, v49, v55
  v_add_f32 v50, v50, v56
  v_add_f32 v51, v51, v57
  v_add_f32 v52, v52, v58
  v_add_f32 v53, v53, v59
  s_nop 1
  v_add_f32_dpp v72, v48, v48 row_ror:8 row_mask:0xf bank_mask:0x3
  v_add_f32_dpp v73, v49, v49 row_ror:8 row_mask:0xf bank_mask:0x3
  v_add_f32_dpp v74, v50, v50 row_ror:8 row_mask:0xf bank_mask:0x3
  v_add_f32_dpp v72, v51, v51 row_ror:8 row_mask:0xf bank_mask:0xc
  v_add_f32_dpp v73, v52, v52 row_ror:8 row_mask:0xf bank_mask:0xc
  v_add_f32_dpp v74, v53, v53 row_ror:8 row_mask:0xf bank_mask:0xc
  v_mov_b32 v75, v104
  v_lshlrev_b32 v92, 4, v0
  ds_write_b128 v92, v[72:75]
  s_waitcnt lgkmcnt(0)
  s_barrier
  s_cmp_lg_u32 s66, 0
  s_cbranch_scc1 L_end
  v_mov_b32 v106, 0
  s_mov_b64 exec, 1
  buffer_atomic_add v106, off, s[56:59], s63 offset:0 sc0
  s_mov_b64 exec, -1
  ds_read_b128 v[108:111], v92 offset:0
  ds_read_b128 v[112:115], v92 offset:1024
  ds_read_b128 v[116:119], v92 offset:2048
  ds_read_b128 v[120:123], v92 offset:3072
  s_waitcnt lgkmcnt(0)
  v_max_f32 v92, v111, v115
  v_max_f32 v92, v92, v119
  v_max_f32 v92, v92, v123
  v_sub_f32 v111, v111, v92
  v_sub_f32 v115, v115, v92
  v_sub_f32 v119, v119, v92
  v_sub_f32 v123, v123, v92
  v_exp_f32 v111, v111
  v_exp_f32 v115, v115
  v_exp_f32 v119, v119
  v_exp_f32 v123, v123
  s_nop 0
  v_add_f32 v93, v111, v115
  v_add_f32 v93, v93, v119
  v_add_f32 v93, v93, v123
  v_rcp_f32 v94, v93
  v_log_f32 v93, v93
  v_mul_f32 v96, v108, v111
  v_mul_f32 v97, v109, v111
  v_mul_f32 v98, v110, v111
  v_fmac_f32 v96, v112, v115
  v_fmac_f32 v97, v113, v115
  v_fmac_f32 v98, v114, v115
  v_fmac_f32 v96, v116, v119
  v_fmac_f32 v97, v117, v119
  v_fmac_f32 v98, v118, v119
  v_fmac_f32 v96, v120, v123
  v_fmac_f32 v97, v121, v123
  v_fmac_f32 v98, v122, v123
  v_mul_f32 v72, v96, v94
  v_mul_f32 v73, v97, v94
  v_mul_f32 v74, v98, v94
  v_add_f32 v75, v93, v92
  s_lshl_b32 s64, s61, 10
  v_lshlrev_b32 v100, 4, v0
  buffer_store_dwordx4 v[72:75], v107, s[52:55], s86 offen sc1
  v_mov_b32 v102, 1
  s_waitcnt vmcnt(1)
  v_readfirstlane_b32 s62, v106
  s_cmp_eq_u32 s62, 7
  s_cbranch_scc1 L_last
  s_waitcnt vmcnt(0)
  s_mov_b64 exec, 1
  buffer_atomic_add v102, off, s[56:59], s63 offset:0 sc0
  s_waitcnt vmcnt(0)
  v_readfirstlane_b32 s62, v102
  s_mov_b64 exec, -1
  s_cmp_lg_u32 s62, 7
  s_cbranch_scc1 L_fin
L_last:
  buffer_load_dwordx4 v[112:115], v107, s[52:55], s87 offen sc1
  buffer_load_dwordx4 v[116:119], v107, s[52:55], s88 offen sc1
  buffer_load_dwordx4 v[120:123], v107, s[52:55], s89 offen sc1
  buffer_load_dwordx4 v[124:127], v107, s[52:55], s90 offen sc1
  buffer_load_dwordx4 v[128:131], v107, s[52:55], s91 offen sc1
  buffer_load_dwordx4 v[132:135], v107, s[52:55], s92 offen sc1
  buffer_load_dwordx4 v[136:139], v107, s[52:55], s93 offen sc1
  s_waitcnt vmcnt(0)
  v_max_f32 v92, v75, v115
  v_max_f32 v92, v92, v119
  v_max_f32 v92, v92, v123
  v_max_f32 v92, v92, v127
  v_max_f32 v92, v92, v131
  v_max_f32 v92, v92, v135
  v_max_f32 v92, v92, v139
  v_max_f32 v92, v92, v87
  v_sub_f32 v75, v75, v92
  v_sub_f32 v115, v115, v92
  v_sub_f32 v119, v119, v92
  v_sub_f32 v123, v123, v92
  v_sub_f32 v127, v127, v92
  v_sub_f32 v131, v131, v92
  v_sub_f32 v135, v135, v92
  v_sub_f32 v139, v139, v92
  v_sub_f32 v87, v87, v92
  v_exp_f32 v75, v75
  v_exp_f32 v115, v115
  v_exp_f32 v119, v119
  v_exp_f32 v123, v123
  v_exp_f32 v127, v127
  v_exp_f32 v131, v131
  v_exp_f32 v135, v135
  v_exp_f32 v139, v139
  v_exp_f32 v87, v87
  s_nop 0
  v_add_f32 v93, v75, v115
  v_add_f32 v93, v93, v119
  v_add_f32 v93, v93, v123
  v_add_f32 v93, v93, v127
  v_add_f32 v93, v93, v131
  v_add_f32 v93, v93, v135
  v_add_f32 v93, v93, v139
  v_add_f32 v93, v93, v87
  v_rcp_f32 v94, v93
  v_log_f32 v93, v93
  v_mul_f32 v96, v72, v75
  v_mul_f32 v97, v73, v75
  v_mul_f32 v98, v74, v75
  v_fmac_f32 v96, v112, v115
  v_fmac_f32 v97, v113, v115
  v_fmac_f32 v98, v114, v115
  v_fmac_f32 v96, v116, v119
  v_fmac_f32 v97, v117, v119
  v_fmac_f32 v98, v118, v119
  v_fmac_f32 v96, v120, v123
  v_fmac_f32 v97, v121, v123
  v_fmac_f32 v98, v122, v123
  v_fmac_f32 v96, v124, v127
  v_fmac_f32 v97, v125, v127
  v_fmac_f32 v98, v126, v127
  v_fmac_f32 v96, v128, v131
  v_fmac_f32 v97, v129, v131
  v_fmac_f32 v98, v130, v131
  v_fmac_f32 v96, v132, v135
  v_fmac_f32 v97, v133, v135
  v_fmac_f32 v98, v134, v135
  v_fmac_f32 v96, v136, v139
  v_fmac_f32 v97, v137, v139
  v_fmac_f32 v98, v138, v139
  v_fmac_f32 v96, v84, v87
  v_fmac_f32 v97, v85, v87
  v_fmac_f32 v98, v86, v87
  v_mul_f32 v48, v96, v94
  v_mul_f32 v49, v97, v94
  v_mul_f32 v50, v98, v94
  v_add_f32 v51, v93, v92
  v_cvt_pk_bf16_f32 v48, v48, v49
  v_cvt_pk_bf16_f32 v50, v50, v50
  buffer_store_short v48, v88, s[48:51], 0 offen
  buffer_store_short_d16_hi v48, v89, s[48:51], 0 offen
  buffer_store_short v50, v90, s[48:51], 0 offen
L_fin:
L_end:
  s_endpgm
.section .rodata,"a"
.p2align 6
.amdhsa_kernel standalone__tree_speculative_verify_tree_attention_over_candidate_token_tree__decode_kernel
  .amdhsa_next_free_vgpr 252
  .amdhsa_next_free_sgpr 96
  .amdhsa_accum_offset 252
  .amdhsa_group_segment_fixed_size 0
  .amdhsa_kernarg_size 72
  .amdhsa_user_sgpr_count 2
  .amdhsa_user_sgpr_kernarg_segment_ptr 1
  .amdhsa_system_sgpr_workgroup_id_x 1
.end_amdhsa_kernel
```
